```python
import torch

def _softmax(x, axis=-1):
    return torch.softmax(x, dim=axis)
def _gelu(x):
    return torch.nn.functional.gelu(x, approximate="tanh")
def _silu(x):
    return torch.nn.functional.silu(x)
def _sigmoid(x):
    return torch.sigmoid(x)
def _layernorm(x, axis=-1, eps=1e-5):
    m = x.mean(dim=axis, keepdim=True)
    v = x.var(dim=axis, keepdim=True, unbiased=False)
    return (x - m) / torch.sqrt(v + eps)
def _scatter_add(tgt, idx, src, axis=0):
    return tgt.clone().index_add_(axis, idx, src)
def _segment_sum(src, seg, n):
    out = torch.zeros((n,) + src.shape[1:], dtype=src.dtype)
    return out.index_add_(0, seg, src)
def _pad(x, pw):
    flat = tuple(v for pair in reversed(pw) for v in pair)
    return torch.nn.functional.pad(x, flat)

kernel_name = 'interleave_layers__gqa_block_cached__gqa_block_cached__decode'

def setup_inputs():

    _w = (lambda a: (lambda t: t.to(torch.bfloat16) if t.is_floating_point() else t)(torch.as_tensor(a)))
    def _A_setup():
        B, Sq, D = 4, 1, 640
        Hq, Hkv, Sk, Dh = 32, 32, 4096, 128
        assert Hq % Hkv == 0, (Hq, Hkv)
        return {
            "x": _w((lambda *s: torch.randn(*s, dtype=torch.bfloat16) * 0.1)(B, Sq, D)),
            "k_cache": _w((lambda *s: torch.randn(*s, dtype=torch.bfloat16) * 0.8)(B, Hkv, Sk, Dh)),
            "v_cache": _w((lambda *s: torch.randn(*s, dtype=torch.bfloat16) * 3.2)(B, Hkv, Sk, Dh)),
            "wq": _w((lambda *s: torch.randn(*s, dtype=torch.bfloat16) * 0.8)(D, Hq * Dh) * (D ** -0.5)),
            "wo": _w((lambda *s: torch.randn(*s, dtype=torch.bfloat16) * 3.2)(Hq * Dh, D) * ((Hq * Dh) ** -0.5)),
        }
    _A_in = _A_setup()

    def _B_setup():
        B, Sq, D = 4, 1, 640
        Hq, Hkv, Sk, Dh = 32, 32, 4096, 128
        assert Hq % Hkv == 0, (Hq, Hkv)
        return {
            "x": _w((lambda *s: torch.randn(*s, dtype=torch.bfloat16) * 0.1)(B, Sq, D)),
            "k_cache": _w((lambda *s: torch.randn(*s, dtype=torch.bfloat16) * 1.6)(B, Hkv, Sk, Dh)),
            "v_cache": _w((lambda *s: torch.randn(*s, dtype=torch.bfloat16) * 1.6)(B, Hkv, Sk, Dh)),
            "wq": _w((lambda *s: torch.randn(*s, dtype=torch.bfloat16) * 1.6)(D, Hq * Dh) * (D ** -0.5)),
            "wo": _w((lambda *s: torch.randn(*s, dtype=torch.bfloat16) * 1.6)(Hq * Dh, D) * ((Hq * Dh) ** -0.5)),
        }
    _B_in = _B_setup()

    return {
        "A_x": _A_in["x"],
        "A_k_cache": _A_in["k_cache"],
        "A_v_cache": _A_in["v_cache"],
        "A_wq": _A_in["wq"],
        "A_wo": _A_in["wo"],
        "B_x": _B_in["x"],
        "B_k_cache": _B_in["k_cache"],
        "B_v_cache": _B_in["v_cache"],
        "B_wq": _B_in["wq"],
        "B_wo": _B_in["wo"],
    }

def reference(A_x, A_k_cache, A_v_cache, A_wq, A_wo, B_x, B_k_cache, B_v_cache, B_wq, B_wo):
    def _A_ref(x, k_cache, v_cache, wq, wo):
        B, Sq, D = x.shape
        Hq, Dh = 32, 128
        Hkv = k_cache.shape[1]
        rep = Hq // Hkv
        q = (lambda x, *d: x.permute(*d))((x @ wq).reshape(B, Sq, Hq, Dh), 0, 2, 1, 3)
        k = (lambda x, n, axis: torch.repeat_interleave(x, n, dim=axis))(k_cache, rep, axis=1)
        v = (lambda x, n, axis: torch.repeat_interleave(x, n, dim=axis))(v_cache, rep, axis=1)
        scores = torch.einsum("bhqd,bhkd->bhqk", q, k) * (Dh ** -0.5)
        p = _softmax(scores, axis=-1)
        o = torch.einsum("bhqk,bhkd->bhqd", p, v)
        return (lambda x, *d: x.permute(*d))(o, 0, 2, 1, 3).reshape(B, Sq, Hq * Dh) @ wo

    def _B_ref(x, k_cache, v_cache, wq, wo):
        B, Sq, D = x.shape
        Hq, Dh = 32, 128
        Hkv = k_cache.shape[1]
        rep = Hq // Hkv
        q = (lambda x, *d: x.permute(*d))((x @ wq).reshape(B, Sq, Hq, Dh), 0, 2, 1, 3)
        k = (lambda x, n, axis: torch.repeat_interleave(x, n, dim=axis))(k_cache, rep, axis=1)
        v = (lambda x, n, axis: torch.repeat_interleave(x, n, dim=axis))(v_cache, rep, axis=1)
        scores = torch.einsum("bhqd,bhkd->bhqk", q, k) * (Dh ** -0.5)
        p = _softmax(scores, axis=-1)
        o = torch.einsum("bhqk,bhkd->bhqd", p, v)
        return (lambda x, *d: x.permute(*d))(o, 0, 2, 1, 3).reshape(B, Sq, Hq * Dh) @ wo

    x = A_x
    x = x + _A_ref(_layernorm(x, axis=-1), A_k_cache, A_v_cache, A_wq, A_wo)
    x = x + _B_ref(_layernorm(x, axis=-1), B_k_cache, B_v_cache, B_wq, B_wo)
    x = x + _A_ref(_layernorm(x, axis=-1), A_k_cache, A_v_cache, A_wq, A_wo)
    x = x + _B_ref(_layernorm(x, axis=-1), B_k_cache, B_v_cache, B_wq, B_wo)
    return x
```

```asm
; @launch grid=(256,1,1) block=(256,1,1) lds=163840
.amdgcn_target "amdgcn-amd-amdhsa--gfx950"
.text
.globl interleave_layers__gqa_block_cached__gqa_block_cached__decode_kernel
.p2align 8
.type interleave_layers__gqa_block_cached__gqa_block_cached__decode_kernel,@function
interleave_layers__gqa_block_cached__gqa_block_cached__decode_kernel:
    s_cmp_ge_u32 s2, 256
    s_cbranch_scc1 L_exit
    s_getpc_b64 s[90:91]
    s_load_dwordx16 s[36:51], s[0:1], 0
    s_load_dwordx8 s[52:59], s[0:1], 64
    s_load_dwordx2 s[60:61], s[0:1], 96
    v_lshrrev_b32 v7, 6, v0
    v_and_b32 v12, 63, v0
    v_readfirstlane_b32 s3, v7
    v_lshlrev_b32 v2, 4, v12
    v_lshlrev_b32 v3, 7, v12
    v_lshrrev_b32 v13, 4, v12
    v_and_b32 v14, 15, v12
    v_and_b32 v1, 0x70, v2
    v_lshrrev_b32 v15, 3, v12
    v_lshl_add_u32 v1, v15, 9, v1
    v_and_b32 v15, 3, v12
    v_lshlrev_b32 v0, 4, v15
    v_lshl_add_u32 v0, v13, 6, v0
    v_bfe_u32 v15, v12, 2, 2
    v_lshl_add_u32 v0, v15, 8, v0
    v_mov_b32 v4, 0x24000
    s_and_b32 s4, s2, 7
    s_lshl_b32 s4, s4, 5
    s_lshr_b32 s5, s2, 3
    s_add_u32 s4, s4, s5
    s_lshr_b32 s5, s4, 3
    s_and_b32 s6, s4, 7
    s_getreg_b32 s83, hwreg(HW_REG_XCC_ID)
    s_and_b32 s83, s83, 15
    s_add_u32 s83, s83, 64
    s_waitcnt lgkmcnt(0)
    s_mov_b32 s24, s60
    s_and_b32 s25, s61, 0xffff
    s_mov_b32 s26, 0x800000
    s_mov_b32 s27, 0x20000
    s_mov_b32 s28, s58
    s_and_b32 s29, s59, 0xffff
    s_mov_b32 s30, 0x100
    s_mov_b32 s31, 0x20000
    s_cmp_eq_u32 s6, 7
    s_cbranch_scc1 L_chain
    s_mov_b32 s8, s38
    s_and_b32 s9, s39, 0xffff
    s_mov_b32 s10, 0x8000000
    s_mov_b32 s11, 0x20000
    s_mov_b32 s12, s40
    s_and_b32 s13, s41, 0xffff
    s_mov_b32 s14, 0x8000000
    s_mov_b32 s15, 0x20000
    s_mov_b32 s16, s48
    s_and_b32 s17, s49, 0xffff
    s_mov_b32 s18, 0x8000000
    s_mov_b32 s19, 0x20000
    s_mov_b32 s20, s50
    s_and_b32 s21, s51, 0xffff
    s_mov_b32 s22, 0x8000000
    s_mov_b32 s23, 0x20000
    s_mov_b32 s92, s42
    s_and_b32 s93, s43, 0xffff
    s_mov_b32 s94, 0x500000
    s_mov_b32 s95, 0x20000
    s_mov_b32 s96, s44
    s_and_b32 s97, s45, 0xffff
    s_mov_b32 s98, 0x500000
    s_mov_b32 s99, 0x20000
    s_mov_b32 s84, s52
    s_and_b32 s85, s53, 0xffff
    s_mov_b32 s86, 0x500000
    s_mov_b32 s87, 0x20000
    s_mov_b32 s32, s54
    s_and_b32 s33, s55, 0xffff
    s_mov_b32 s34, 0x500000
    s_mov_b32 s35, 0x20000
    s_mul_i32 s44, s6, 36
    s_min_u32 s45, s6, 4
    s_add_u32 s44, s44, s45
    s_add_u32 s44, s44, s3
    s_lshl_b32 s36, s5, 20
    s_lshl_b32 s44, s44, 12
    s_add_u32 s36, s36, s44
    s_mul_i32 s37, s3, 9216
    s_mov_b32 s38, s36
    s_add_u32 s39, s38, 32768
    buffer_load_dwordx4 a[112:115], v1, s[12:15], s39 offen offset:0 nt
    buffer_load_dwordx4 a[116:119], v1, s[12:15], s39 offen offset:128 nt
    buffer_load_dwordx4 a[120:123], v1, s[12:15], s39 offen offset:256 nt
    buffer_load_dwordx4 a[124:127], v1, s[12:15], s39 offen offset:384 nt
    v_mov_b32 v20, -1
    v_mov_b32 v21, -1
    v_mov_b32 v22, -1
    v_mov_b32 v23, -1
    s_lshl_b32 s44, s2, 2
    s_add_u32 s44, s44, s3
    s_lshl_b32 s44, s44, 12
    buffer_store_dwordx4 v[20:23], v2, s[24:27], s44 offen offset:0 sc1
    buffer_store_dwordx4 v[20:23], v2, s[24:27], s44 offen offset:1024 sc1
    buffer_store_dwordx4 v[20:23], v2, s[24:27], s44 offen offset:2048 sc1
    buffer_store_dwordx4 v[20:23], v2, s[24:27], s44 offen offset:3072 sc1
    s_and_b32 s44, s5, 3
    s_mul_i32 s44, s44, 7
    s_add_u32 s44, s44, s6
    s_lshl_b32 s44, s44, 2
    s_add_u32 s44, s44, s3
    s_and_b32 s45, s2, 7
    s_cmp_ge_u32 s44, 80
    s_cbranch_scc1 Lwn_2
    s_add_i32 s44, s44, 0
    s_lshl_b32 s44, s44, 16
    s_lshl_b32 s45, s45, 10
    v_lshrrev_b32 v44, 7, v2
    v_lshlrev_b32 v44, 13, v44
    v_and_b32 v45, 0x70, v2
    v_lshl_add_u32 v44, v45, 3, v44
    s_add_u32 s44, s44, s45
    buffer_load_dword v5, v44, s[92:95], s44 offen
    s_branch Lwt_1
Lwn_2:
    s_cmp_ge_u32 s44, 112
    s_cbranch_scc1 Lwn_3
    s_add_i32 s44, s44, -80
    s_lshl_b32 s44, s44, 13
    s_mul_i32 s45, s45, 655360
    v_lshlrev_b32 v44, 3, v2
    s_add_u32 s44, s44, s45
    buffer_load_dword v5, v44, s[96:99], s44 offen
    s_branch Lwt_1
Lwn_3:
Lwt_1:
    s_mul_i32 s61, s3, 0xfffff400
    s_add_u32 s61, s61, 147456
    s_cmp_lt_u32 s6, 4
    s_cselect_b32 s80, 0x00020002, 0
    s_mov_b32 s81, s80
    v_and_b32 v6, 7, v12
    v_lshlrev_b32 v6, 5, v6
    v_and_b32 v15, 1, v13
    v_lshl_add_u32 v6, v15, 4, v6
    v_lshrrev_b32 v15, 1, v13
    v_lshl_add_u32 v6, v15, 9, v6
    v_add_u32 v6, 0x24000, v6
    v_mov_b32 v16, 0
    v_lshl_add_u32 v17, v7, 2, v4
    ds_write_b32 v17, v16 offset:10368
    v_and_b32 v15, 1, v12
    v_lshlrev_b32 v15, 4, v15
    v_mov_b32 v16, 0xffff
    v_lshlrev_b32 v16, v15, v16
    v_bfe_u32 v15, v14, 1, 2
    v_cmp_eq_u32 vcc, 0, v15
    s_nop 1
    v_cndmask_b32 v8, 0, v16, vcc
    v_cmp_eq_u32 vcc, 1, v15
    s_nop 1
    v_cndmask_b32 v9, 0, v16, vcc
    v_cmp_eq_u32 vcc, 2, v15
    s_nop 1
    v_cndmask_b32 v10, 0, v16, vcc
    v_cmp_eq_u32 vcc, 3, v15
    s_nop 1
    v_cndmask_b32 v11, 0, v16, vcc
    s_mov_b32 s43, 1048576
    s_mov_b32 s7, 0
    s_mov_b32 s51, 0
    s_lshl_b32 s50, s3, 8
    s_add_u32 s50, s50, 162816
    v_mov_b32 v16, 0
    ds_write_b32 v4, v16 offset:10384
    ds_write_b32 v4, v16 offset:10388
    ds_write_b32 v4, v16 offset:10392
    s_mov_b32 s101, 0
    v_mov_b32 v36, 0
    v_mov_b32 v37, 0
    v_mov_b32 v38, 0
    v_mov_b32 v39, 0
    v_add_u32 v44, s37, v2
    ds_write_b128 v44, v[36:39] offset:45056
    v_add_u32 v44, 73728, v44
    ds_write_b128 v44, v[36:39] offset:45056
    s_mov_b32 s62, 0x11111111
    s_mov_b32 s63, 0x11111111
    s_mov_b32 s70, 0xf000f
    s_mov_b32 s71, 0xf000f
    s_mov_b32 s64, 0x22222222
    s_mov_b32 s65, 0x22222222
    s_mov_b32 s72, 0xf000f0
    s_mov_b32 s73, 0xf000f0
    s_mov_b32 s66, 0x44444444
    s_mov_b32 s67, 0x44444444
    s_mov_b32 s74, 0xf000f00
    s_mov_b32 s75, 0xf000f00
    s_mov_b32 s68, 0x88888888
    s_mov_b32 s69, 0x88888888
    s_mov_b32 s76, 0xf000f000
    s_mov_b32 s77, 0xf000f000
    s_mov_b32 s60, 0
    s_mov_b32 s82, 0x3e0293ee
    s_mov_b32 s41, 0
    s_mov_b32 s55, 0
    s_mov_b32 s100, 0
    s_waitcnt lgkmcnt(0)
    s_barrier
    v_mov_b32 v24, 1
    v_mov_b32 v25, s83
    v_mov_b32 v26, 0
    s_waitcnt vmcnt(1)
    s_mov_b64 exec, 1
    ds_add_rtn_u32 v24, v4, v24 offset:10392
    s_waitcnt lgkmcnt(0)
    v_readfirstlane_b32 s44, v24
    s_nop 0
    s_cmp_lg_u32 s44, 3
    s_cbranch_scc1 Lcl_4
    buffer_store_byte v25, v26, s[28:31], s4 offen sc1
Lcl_4:
    s_mov_b64 exec, -1
    s_add_u32 s39, s38, 0
    s_add_u32 m0, s37, 0
    s_waitcnt vmcnt(5)
    buffer_load_dwordx4 v0, s[8:11], s39 offen offset:0 nt lds
    s_waitcnt vmcnt(5)
    buffer_load_dwordx4 v0, s[8:11], s39 offen offset:1024 nt lds
    s_waitcnt vmcnt(5)
    buffer_load_dwordx4 v0, s[8:11], s39 offen offset:2048 nt lds
    s_waitcnt vmcnt(5)
    buffer_load_dwordx4 v0, s[8:11], s39 offen offset:3072 nt lds
    s_and_b32 s44, s5, 3
    s_mul_i32 s44, s44, 7
    s_add_u32 s44, s44, s6
    s_lshl_b32 s44, s44, 2
    s_add_u32 s44, s44, s3
    s_and_b32 s45, s2, 7
    s_cmp_ge_u32 s44, 48
    s_cbranch_scc1 Lwn_6
    s_add_i32 s44, s44, 32
    s_lshl_b32 s44, s44, 13
    s_mul_i32 s45, s45, 655360
    v_lshlrev_b32 v44, 3, v2
    s_add_u32 s44, s44, s45
    buffer_load_dword v5, v44, s[96:99], s44 offen
    s_branch Lwt_5
Lwn_6:
    s_cmp_ge_u32 s44, 112
    s_cbranch_scc1 Lwn_7
    s_add_i32 s44, s44, -48
    s_lshl_b32 s44, s44, 16
    s_lshl_b32 s45, s45, 10
    v_lshrrev_b32 v44, 7, v2
    v_lshlrev_b32 v44, 13, v44
    v_and_b32 v45, 0x70, v2
    v_lshl_add_u32 v44, v45, 3, v44
    s_add_u32 s44, s44, s45
    buffer_load_dword v5, v44, s[84:87], s44 offen
    s_branch Lwt_5
Lwn_7:
Lwt_5:
    s_add_u32 s39, s38, 16384
    s_add_u32 m0, s37, 4096
    s_waitcnt vmcnt(5)
    buffer_load_dwordx4 v0, s[8:11], s39 offen offset:0 nt lds
    s_waitcnt vmcnt(5)
    buffer_load_dwordx4 v0, s[8:11], s39 offen offset:1024 nt lds
    s_waitcnt vmcnt(5)
    buffer_load_dwordx4 v0, s[8:11], s39 offen offset:2048 nt lds
    s_waitcnt vmcnt(5)
    buffer_load_dwordx4 v0, s[8:11], s39 offen offset:3072 nt lds
    s_add_u32 s39, s38, 49152
    s_waitcnt vmcnt(5)
    buffer_load_dwordx4 a[128:131], v1, s[12:15], s39 offen offset:0 nt
    s_waitcnt vmcnt(5)
    buffer_load_dwordx4 a[132:135], v1, s[12:15], s39 offen offset:128 nt
    s_waitcnt vmcnt(5)
    buffer_load_dwordx4 a[136:139], v1, s[12:15], s39 offen offset:256 nt
    s_waitcnt vmcnt(5)
    buffer_load_dwordx4 a[140:143], v1, s[12:15], s39 offen offset:384 nt
    s_and_b32 s44, s5, 3
    s_mul_i32 s44, s44, 7
    s_add_u32 s44, s44, s6
    s_lshl_b32 s44, s44, 2
    s_add_u32 s44, s44, s3
    s_and_b32 s45, s2, 7
    s_cmp_ge_u32 s44, 16
    s_cbranch_scc1 Lwn_9
    s_add_i32 s44, s44, 64
    s_lshl_b32 s44, s44, 16
    s_lshl_b32 s45, s45, 10
    v_lshrrev_b32 v44, 7, v2
    v_lshlrev_b32 v44, 13, v44
    v_and_b32 v45, 0x70, v2
    v_lshl_add_u32 v44, v45, 3, v44
    s_add_u32 s44, s44, s45
    buffer_load_dword v5, v44, s[84:87], s44 offen
    s_branch Lwt_8
Lwn_9:
    s_cmp_ge_u32 s44, 96
    s_cbranch_scc1 Lwn_10
    s_add_i32 s44, s44, -16
    s_lshl_b32 s44, s44, 13
    s_mul_i32 s45, s45, 655360
    v_lshlrev_b32 v44, 3, v2
    s_add_u32 s44, s44, s45
    buffer_load_dword v5, v44, s[32:35], s44 offen
    s_branch Lwt_8
Lwn_10:
Lwt_8:
L_dloop:
    s_lshl_b32 s38, s7, 25
    s_add_u32 s38, s38, s36
    s_mov_b32 s52, s41
    s_mov_b32 s40, s38
    s_mov_b32 s41, 0
    s_lshl_b32 s44, s7, 7
    s_add_u32 s44, s44, s5
    s_lshl_b32 s56, s44, 11
    s_add_u32 s56, s56, 2424832
    s_lshl_b32 s57, s44, 6
    s_add_u32 s57, s57, 3536896
    s_lshl_b32 s48, s3, 10
    s_add_u32 s48, s48, 4096
    s_mov_b32 s59, 3
    s_lshl_b32 s49, s7, 2
    s_sub_u32 s49, s49, 1
    s_mov_b32 s58, 157312
    s_mov_b32 s54, 156544
    s_cmp_eq_u32 s7, 4
    s_cbranch_scc1 L_dlast
    s_cmp_ge_u32 s52, 3
    s_cselect_b32 s53, 13, 5
    s_cmp_ge_u32 s6, 4
    s_cbranch_scc1 Lnx_11
    s_add_u32 s39, s38, s61
    s_add_u32 m0, s37, 8192
    s_nop 0
    buffer_load_dwordx4 v0, s[8:11], s39 offen nt lds
Lnx_11:
    s_cmp_ge_u32 s52, 3
    s_cselect_b32 s53, 13, 5
    s_cmp_ge_u32 s6, 4
    s_cbranch_scc1 Lnx_12
    s_add_u32 s39, s38, s61
    s_add_u32 m0, s37, 45056
    s_nop 0
    buffer_load_dwordx4 v2, s[12:15], s39 offen nt lds
Lnx_12:
    s_cmp_ge_u32 s52, 3
    s_cselect_b32 s53, 13, 5
    s_add_u32 s39, s38, 32768
Lp_13:
    s_getreg_b32 s44, hwreg(HW_REG_IB_STS)
    s_and_b32 s44, s44, 0xc0000f
    s_cmp_gt_u32 s44, s53
    s_cbranch_scc1 Lp_13
    buffer_load_dwordx4 a[0:3], v0, s[8:11], s39 offen offset:0 nt
Lp_14:
    s_getreg_b32 s44, hwreg(HW_REG_IB_STS)
    s_and_b32 s44, s44, 0xc0000f
    s_cmp_gt_u32 s44, s53
    s_cbranch_scc1 Lp_14
    buffer_load_dwordx4 a[4:7], v0, s[8:11], s39 offen offset:1024 nt
Lp_15:
    s_getreg_b32 s44, hwreg(HW_REG_IB_STS)
    s_and_b32 s44, s44, 0xc0000f
    s_cmp_gt_u32 s44, s53
    s_cbranch_scc1 Lp_15
    buffer_load_dwordx4 a[8:11], v0, s[8:11], s39 offen offset:2048 nt
Lp_16:
    s_getreg_b32 s44, hwreg(HW_REG_IB_STS)
    s_and_b32 s44, s44, 0xc0000f
    s_cmp_gt_u32 s44, s53
    s_cbranch_scc1 Lp_16
    buffer_load_dwordx4 a[12:15], v0, s[8:11], s39 offen offset:3072 nt
    s_cmp_ge_u32 s52, 4
    s_cselect_b32 s53, 13, 5
    s_add_u32 s39, s38, 49152
Lp_17:
    s_getreg_b32 s44, hwreg(HW_REG_IB_STS)
    s_and_b32 s44, s44, 0xc0000f
    s_cmp_gt_u32 s44, s53
    s_cbranch_scc1 Lp_17
    buffer_load_dwordx4 a[16:19], v0, s[8:11], s39 offen offset:0 nt
Lp_18:
    s_getreg_b32 s44, hwreg(HW_REG_IB_STS)
    s_and_b32 s44, s44, 0xc0000f
    s_cmp_gt_u32 s44, s53
    s_cbranch_scc1 Lp_18
    buffer_load_dwordx4 a[20:23], v0, s[8:11], s39 offen offset:1024 nt
Lp_19:
    s_getreg_b32 s44, hwreg(HW_REG_IB_STS)
    s_and_b32 s44, s44, 0xc0000f
    s_cmp_gt_u32 s44, s53
    s_cbranch_scc1 Lp_19
    buffer_load_dwordx4 a[24:27], v0, s[8:11], s39 offen offset:2048 nt
Lp_20:
    s_getreg_b32 s44, hwreg(HW_REG_IB_STS)
    s_and_b32 s44, s44, 0xc0000f
    s_cmp_gt_u32 s44, s53
    s_cbranch_scc1 Lp_20
    buffer_load_dwordx4 a[28:31], v0, s[8:11], s39 offen offset:3072 nt
    s_barrier
    s_cmp_ge_u32 s52, 5
    s_cselect_b32 s53, 13, 5
    s_add_u32 s39, s38, 0
    s_add_u32 m0, s37, 36864
Lp_21:
    s_getreg_b32 s44, hwreg(HW_REG_IB_STS)
    s_and_b32 s44, s44, 0xc0000f
    s_cmp_gt_u32 s44, s53
    s_cbranch_scc1 Lp_21
    buffer_load_dwordx4 v1, s[12:15], s39 offen offset:0 nt lds
    s_add_u32 m0, s37, 37760
Lp_22:
    s_getreg_b32 s44, hwreg(HW_REG_IB_STS)
    s_and_b32 s44, s44, 0xc0000f
    s_cmp_gt_u32 s44, s53
    s_cbranch_scc1 Lp_22
    buffer_load_dwordx4 v1, s[12:15], s39 offen offset:128 nt lds
    s_add_u32 m0, s37, 38656
Lp_23:
    s_getreg_b32 s44, hwreg(HW_REG_IB_STS)
    s_and_b32 s44, s44, 0xc0000f
    s_cmp_gt_u32 s44, s53
    s_cbranch_scc1 Lp_23
    buffer_load_dwordx4 v1, s[12:15], s39 offen offset:256 nt lds
    s_add_u32 m0, s37, 39552
Lp_24:
    s_getreg_b32 s44, hwreg(HW_REG_IB_STS)
    s_and_b32 s44, s44, 0xc0000f
    s_cmp_gt_u32 s44, s53
    s_cbranch_scc1 Lp_24
    buffer_load_dwordx4 v1, s[12:15], s39 offen offset:384 nt lds
    s_cmp_ge_u32 s52, 5
    s_cselect_b32 s53, 13, 5
    s_add_u32 s39, s38, 65536
Lp_25:
    s_getreg_b32 s44, hwreg(HW_REG_IB_STS)
    s_and_b32 s44, s44, 0xc0000f
    s_cmp_gt_u32 s44, s53
    s_cbranch_scc1 Lp_25
    buffer_load_dwordx4 a[32:35], v0, s[8:11], s39 offen offset:0 nt
Lp_26:
    s_getreg_b32 s44, hwreg(HW_REG_IB_STS)
    s_and_b32 s44, s44, 0xc0000f
    s_cmp_gt_u32 s44, s53
    s_cbranch_scc1 Lp_26
    buffer_load_dwordx4 a[36:39], v0, s[8:11], s39 offen offset:1024 nt
Lp_27:
    s_getreg_b32 s44, hwreg(HW_REG_IB_STS)
    s_and_b32 s44, s44, 0xc0000f
    s_cmp_gt_u32 s44, s53
    s_cbranch_scc1 Lp_27
    buffer_load_dwordx4 a[40:43], v0, s[8:11], s39 offen offset:2048 nt
Lp_28:
    s_getreg_b32 s44, hwreg(HW_REG_IB_STS)
    s_and_b32 s44, s44, 0xc0000f
    s_cmp_gt_u32 s44, s53
    s_cbranch_scc1 Lp_28
    buffer_load_dwordx4 a[44:47], v0, s[8:11], s39 offen offset:3072 nt
    s_cmp_ge_u32 s52, 6
    s_cselect_b32 s53, 13, 5
    s_add_u32 s39, s38, 81920
Lp_29:
    s_getreg_b32 s44, hwreg(HW_REG_IB_STS)
    s_and_b32 s44, s44, 0xc0000f
    s_cmp_gt_u32 s44, s53
    s_cbranch_scc1 Lp_29
    buffer_load_dwordx4 a[48:51], v0, s[8:11], s39 offen offset:0 nt
Lp_30:
    s_getreg_b32 s44, hwreg(HW_REG_IB_STS)
    s_and_b32 s44, s44, 0xc0000f
    s_cmp_gt_u32 s44, s53
    s_cbranch_scc1 Lp_30
    buffer_load_dwordx4 a[52:55], v0, s[8:11], s39 offen offset:1024 nt
Lp_31:
    s_getreg_b32 s44, hwreg(HW_REG_IB_STS)
    s_and_b32 s44, s44, 0xc0000f
    s_cmp_gt_u32 s44, s53
    s_cbranch_scc1 Lp_31
    buffer_load_dwordx4 a[56:59], v0, s[8:11], s39 offen offset:2048 nt
Lp_32:
    s_getreg_b32 s44, hwreg(HW_REG_IB_STS)
    s_and_b32 s44, s44, 0xc0000f
    s_cmp_gt_u32 s44, s53
    s_cbranch_scc1 Lp_32
    buffer_load_dwordx4 a[60:63], v0, s[8:11], s39 offen offset:3072 nt
    s_cmp_ge_u32 s52, 7
    s_cselect_b32 s53, 13, 5
    s_add_u32 s39, s38, 98304
Lp_33:
    s_getreg_b32 s44, hwreg(HW_REG_IB_STS)
    s_and_b32 s44, s44, 0xc0000f
    s_cmp_gt_u32 s44, s53
    s_cbranch_scc1 Lp_33
    buffer_load_dwordx4 a[64:67], v0, s[8:11], s39 offen offset:0 nt
Lp_34:
    s_getreg_b32 s44, hwreg(HW_REG_IB_STS)
    s_and_b32 s44, s44, 0xc0000f
    s_cmp_gt_u32 s44, s53
    s_cbranch_scc1 Lp_34
    buffer_load_dwordx4 a[68:71], v0, s[8:11], s39 offen offset:1024 nt
Lp_35:
    s_getreg_b32 s44, hwreg(HW_REG_IB_STS)
    s_and_b32 s44, s44, 0xc0000f
    s_cmp_gt_u32 s44, s53
    s_cbranch_scc1 Lp_35
    buffer_load_dwordx4 a[72:75], v0, s[8:11], s39 offen offset:2048 nt
Lp_36:
    s_getreg_b32 s44, hwreg(HW_REG_IB_STS)
    s_and_b32 s44, s44, 0xc0000f
    s_cmp_gt_u32 s44, s53
    s_cbranch_scc1 Lp_36
    buffer_load_dwordx4 a[76:79], v0, s[8:11], s39 offen offset:3072 nt
    s_barrier
    s_cmp_ge_u32 s52, 8
    s_cselect_b32 s53, 13, 5
    s_add_u32 s39, s38, 65536
Lp_37:
    s_getreg_b32 s44, hwreg(HW_REG_IB_STS)
    s_and_b32 s44, s44, 0xc0000f
    s_cmp_gt_u32 s44, s53
    s_cbranch_scc1 Lp_37
    buffer_load_dwordx4 a[144:147], v1, s[12:15], s39 offen offset:0 nt
Lp_38:
    s_getreg_b32 s44, hwreg(HW_REG_IB_STS)
    s_and_b32 s44, s44, 0xc0000f
    s_cmp_gt_u32 s44, s53
    s_cbranch_scc1 Lp_38
    buffer_load_dwordx4 a[148:151], v1, s[12:15], s39 offen offset:128 nt
Lp_39:
    s_getreg_b32 s44, hwreg(HW_REG_IB_STS)
    s_and_b32 s44, s44, 0xc0000f
    s_cmp_gt_u32 s44, s53
    s_cbranch_scc1 Lp_39
    buffer_load_dwordx4 a[152:155], v1, s[12:15], s39 offen offset:256 nt
Lp_40:
    s_getreg_b32 s44, hwreg(HW_REG_IB_STS)
    s_and_b32 s44, s44, 0xc0000f
    s_cmp_gt_u32 s44, s53
    s_cbranch_scc1 Lp_40
    buffer_load_dwordx4 a[156:159], v1, s[12:15], s39 offen offset:384 nt
    s_cmp_lg_u32 s7, 0
    s_cbranch_scc1 Lfo_41
    v_lshrrev_b32 v44, 2, v2
    buffer_load_dword v20, v44, s[28:31], 0 offen sc1
Lfo_41:
    s_cmp_ge_u32 s52, 8
    s_cselect_b32 s53, 13, 5
    s_add_u32 s39, s38, 114688
Lp_42:
    s_getreg_b32 s44, hwreg(HW_REG_IB_STS)
    s_and_b32 s44, s44, 0xc0000f
    s_cmp_gt_u32 s44, s53
    s_cbranch_scc1 Lp_42
    buffer_load_dwordx4 a[80:83], v0, s[8:11], s39 offen offset:0 nt
Lp_43:
    s_getreg_b32 s44, hwreg(HW_REG_IB_STS)
    s_and_b32 s44, s44, 0xc0000f
    s_cmp_gt_u32 s44, s53
    s_cbranch_scc1 Lp_43
    buffer_load_dwordx4 a[84:87], v0, s[8:11], s39 offen offset:1024 nt
Lp_44:
    s_getreg_b32 s44, hwreg(HW_REG_IB_STS)
    s_and_b32 s44, s44, 0xc0000f
    s_cmp_gt_u32 s44, s53
    s_cbranch_scc1 Lp_44
    buffer_load_dwordx4 a[88:91], v0, s[8:11], s39 offen offset:2048 nt
Lp_45:
    s_getreg_b32 s44, hwreg(HW_REG_IB_STS)
    s_and_b32 s44, s44, 0xc0000f
    s_cmp_gt_u32 s44, s53
    s_cbranch_scc1 Lp_45
    buffer_load_dwordx4 a[92:95], v0, s[8:11], s39 offen offset:3072 nt
    s_cmp_ge_u32 s52, 9
    s_cselect_b32 s53, 13, 5
    s_add_u32 s39, s38, 131072
Lp_46:
    s_getreg_b32 s44, hwreg(HW_REG_IB_STS)
    s_and_b32 s44, s44, 0xc0000f
    s_cmp_gt_u32 s44, s53
    s_cbranch_scc1 Lp_46
    buffer_load_dwordx4 a[96:99], v0, s[8:11], s39 offen offset:0 nt
Lp_47:
    s_getreg_b32 s44, hwreg(HW_REG_IB_STS)
    s_and_b32 s44, s44, 0xc0000f
    s_cmp_gt_u32 s44, s53
    s_cbranch_scc1 Lp_47
    buffer_load_dwordx4 a[100:103], v0, s[8:11], s39 offen offset:1024 nt
Lp_48:
    s_getreg_b32 s44, hwreg(HW_REG_IB_STS)
    s_and_b32 s44, s44, 0xc0000f
    s_cmp_gt_u32 s44, s53
    s_cbranch_scc1 Lp_48
    buffer_load_dwordx4 a[104:107], v0, s[8:11], s39 offen offset:2048 nt
Lp_49:
    s_getreg_b32 s44, hwreg(HW_REG_IB_STS)
    s_and_b32 s44, s44, 0xc0000f
    s_cmp_gt_u32 s44, s53
    s_cbranch_scc1 Lp_49
    buffer_load_dwordx4 a[108:111], v0, s[8:11], s39 offen offset:3072 nt
    s_cmp_lg_u32 s7, 0
    s_cbranch_scc1 Lfo_50
    s_mov_b32 s42, 0
    s_waitcnt vmcnt(8)
    s_branch Lfc_53
Lfw_51:
    v_lshrrev_b32 v44, 2, v2
    buffer_load_dword v20, v44, s[28:31], 0 offen sc1
    s_waitcnt vmcnt(0)
Lfc_53:
    s_mul_i32 s44, s83, 0x01010101
    v_cmp_ne_u32 s[46:47], s44, v20
    v_and_b32 v20, 0x40404040, v20
    v_cmp_ne_u32 vcc, 0x40404040, v20
    s_nop 0
    s_cbranch_vccz Lfo_52
    s_sleep 32
    s_add_u32 s42, s42, 1
    s_cmp_lt_u32 s42, s43
    s_cbranch_scc1 Lfw_51
    s_mov_b32 s43, 0
Lfo_52:
    s_and_b32 s44, s2, 7
    s_lshl_b32 s44, s44, 3
    s_lshr_b64 s[46:47], s[46:47], s44
    s_and_b32 s46, s46, 0xff
    s_cselect_b32 s51, 0, 1
    s_lshl_b32 s45, s5, 11
    s_add_u32 s45, s45, 3571712
    buffer_load_dwordx4 v[20:23], v2, s[24:27], s45 offen sc1
    buffer_load_dwordx4 v[24:27], v2, s[24:27], s45 offen offset:1024 sc1
Lfo_50:
    s_add_u32 s39, s38, 16384
    s_add_u32 m0, s37, 40960
    s_waitcnt vmcnt(5)
    buffer_load_dwordx4 v1, s[12:15], s39 offen offset:0 nt lds
    s_add_u32 m0, s37, 41856
    s_waitcnt vmcnt(5)
    buffer_load_dwordx4 v1, s[12:15], s39 offen offset:128 nt lds
    s_add_u32 m0, s37, 42752
    s_waitcnt vmcnt(5)
    buffer_load_dwordx4 v1, s[12:15], s39 offen offset:256 nt lds
    s_add_u32 m0, s37, 43648
    s_waitcnt vmcnt(5)
    buffer_load_dwordx4 v1, s[12:15], s39 offen offset:384 nt lds
    s_barrier
    s_add_u32 s39, s38, 81920
    s_waitcnt vmcnt(5)
    buffer_load_dwordx4 a[160:163], v1, s[12:15], s39 offen offset:0 nt
    s_waitcnt vmcnt(5)
    buffer_load_dwordx4 a[164:167], v1, s[12:15], s39 offen offset:128 nt
    s_waitcnt vmcnt(5)
    buffer_load_dwordx4 a[168:171], v1, s[12:15], s39 offen offset:256 nt
    s_waitcnt vmcnt(5)
    buffer_load_dwordx4 a[172:175], v1, s[12:15], s39 offen offset:384 nt
    s_cmp_lg_u32 s7, 0
    s_cbranch_scc1 Lfo_54
    s_mov_b32 s42, 0
    s_waitcnt vmcnt(8)
    s_branch Lcc_57
Lcs_55:
    s_lshl_b32 s45, s5, 11
    s_add_u32 s45, s45, 3571712
    buffer_load_dwordx4 v[20:23], v2, s[24:27], s45 offen sc1
    buffer_load_dwordx4 v[24:27], v2, s[24:27], s45 offen offset:1024 sc1
    s_waitcnt vmcnt(0)
Lcc_57:
    v_max3_u32 v44, v20, v21, v22
    v_max3_u32 v44, v44, v23, v24
    v_max3_u32 v44, v44, v25, v26
    v_max_u32 v44, v44, v27
    v_cmp_eq_u32 vcc, -1, v44
    s_nop 0
    s_cbranch_vccz Lco_56
    s_add_u32 s42, s42, 1
    s_cmp_lt_u32 s42, s43
    s_cbranch_scc1 Lcs_55
    s_mov_b32 s43, 0
Lco_56:
    v_pk_add_f32 v[20:21], v[20:21], v[24:25]
    v_pk_add_f32 v[22:23], v[22:23], v[26:27]
    s_nop 1
    v_permlane32_swap_b32 v20, v22
    v_permlane32_swap_b32 v21, v23
    v_add_f32 v20, v20, v22
    v_add_f32 v21, v21, v23
    v_lshrrev_b32 v44, 1, v2
    v_add_u32 v44, v44, v4
    ds_write_b64 v44, v[20:21] offset:9344
    s_lshl_b32 s44, s7, 7
    s_add_u32 s44, s44, s5
    s_lshl_b32 s56, s44, 11
    s_add_u32 s56, s56, 2490368
    s_lshl_b32 s57, s44, 6
    s_add_u32 s57, s57, 3538944
Lfo_54:
    v_and_b32 v44, 0x30, v2
    buffer_load_dwordx4 v[48:51], v2, s[24:27], s56 offen sc1
    buffer_load_dwordx4 v[52:55], v2, s[24:27], s56 offen offset:1024 sc1
    buffer_load_dwordx2 v[46:47], v44, s[24:27], s57 offen sc1
    s_add_u32 s39, s38, 98304
    s_waitcnt vmcnt(8)
    buffer_load_dwordx4 a[176:179], v1, s[12:15], s39 offen offset:0 nt
    s_waitcnt vmcnt(8)
    buffer_load_dwordx4 a[180:183], v1, s[12:15], s39 offen offset:128 nt
    s_waitcnt vmcnt(8)
    buffer_load_dwordx4 a[184:187], v1, s[12:15], s39 offen offset:256 nt
    s_waitcnt vmcnt(8)
    buffer_load_dwordx4 a[188:191], v1, s[12:15], s39 offen offset:384 nt
    s_add_u32 s39, s38, 114688
    s_waitcnt vmcnt(15)
    buffer_load_dwordx4 a[192:195], v1, s[12:15], s39 offen offset:0 nt
    s_waitcnt vmcnt(15)
    buffer_load_dwordx4 a[196:199], v1, s[12:15], s39 offen offset:128 nt
    s_waitcnt vmcnt(15)
    buffer_load_dwordx4 a[200:203], v1, s[12:15], s39 offen offset:256 nt
    s_waitcnt vmcnt(15)
    buffer_load_dwordx4 a[204:207], v1, s[12:15], s39 offen offset:384 nt
    s_add_u32 s39, s38, 131072
    s_waitcnt vmcnt(15)
    buffer_load_dwordx4 a[208:211], v1, s[12:15], s39 offen offset:0 nt
    s_waitcnt vmcnt(15)
    buffer_load_dwordx4 a[212:215], v1, s[12:15], s39 offen offset:128 nt
    s_waitcnt vmcnt(15)
    buffer_load_dwordx4 a[216:219], v1, s[12:15], s39 offen offset:256 nt
    s_waitcnt vmcnt(15)
    buffer_load_dwordx4 a[220:223], v1, s[12:15], s39 offen offset:384 nt
    s_mov_b32 s47, 0
    s_mov_b32 s55, 0
    s_cmp_eq_u32 s7, 0
    s_cbranch_scc1 L_dno4a
    s_mov_b32 s42, 0
    s_add_u32 s101, s101, 1
Lwo_63:
    s_add_u32 s45, s55, 12
    s_min_u32 s45, s45, 15
    s_nop 1
    s_getreg_b32 s44, hwreg(HW_REG_IB_STS)
    s_and_b32 s44, s44, 0xc0000f
    s_cmp_le_u32 s44, s45
    s_cbranch_scc1 Ldn_64
    s_cmp_ge_u32 s41, s47
    s_cbranch_scc1 Lwo_63
    s_min_u32 s46, s44, s41
    s_mul_i32 s46, s46, 3
    s_add_u32 s44, s44, s46
    s_cmp_gt_u32 s44, 4
    s_cbranch_scc1 Lwo_63
    s_mov_b32 exec_hi, 0
    buffer_load_dword v5, v3, s[16:19], s40 offen
    s_mov_b64 exec, -1
    s_add_u32 s41, s41, 1
    s_add_u32 s55, s55, 1
    s_add_u32 s100, s100, 1
    s_add_u32 s44, s40, 16384
    s_and_b32 s44, s44, 0x3fffff
    s_andn2_b32 s40, s40, 0x3fffff
    s_or_b32 s40, s40, s44
    s_branch Lwo_63
Ldn_64:
    s_branch Lqc_60
Lwq_58:
    v_and_b32 v44, 0x30, v2
    buffer_load_dwordx4 v[48:51], v2, s[24:27], s56 offen sc1
    buffer_load_dwordx4 v[52:55], v2, s[24:27], s56 offen offset:1024 sc1
    buffer_load_dwordx2 v[46:47], v44, s[24:27], s57 offen sc1
    s_add_u32 s55, s55, 3
    s_mov_b32 s100, 0
Lwo_66:
    ds_read_b32 v45, v4 offset:10384
    s_add_u32 s45, s100, 0
    s_min_u32 s45, s45, 15
    s_nop 1
    s_getreg_b32 s44, hwreg(HW_REG_IB_STS)
    s_and_b32 s44, s44, 0xc0000f
    s_cmp_le_u32 s44, s45
    s_cbranch_scc1 Ldn_67
    s_cmp_ge_u32 s41, s47
    s_cbranch_scc1 Lsk_68
    s_sub_u32 s46, s44, s100
    s_min_u32 s46, s46, 3
    s_sub_u32 s44, s44, s46
    s_min_u32 s46, s44, s41
    s_mul_i32 s46, s46, 3
    s_add_u32 s44, s44, s46
    s_cmp_gt_u32 s44, 4
    s_cbranch_scc1 Lsk_68
    s_mov_b32 exec_hi, 0
    buffer_load_dword v5, v3, s[16:19], s40 offen
    s_mov_b64 exec, -1
    s_add_u32 s41, s41, 1
    s_add_u32 s55, s55, 1
    s_add_u32 s100, s100, 1
    s_add_u32 s44, s40, 16384
    s_and_b32 s44, s44, 0x3fffff
    s_andn2_b32 s40, s40, 0x3fffff
    s_or_b32 s40, s40, s44
Lsk_68:
    s_waitcnt lgkmcnt(0)
    v_readfirstlane_b32 s44, v45
    s_nop 0
    s_cmp_ge_u32 s44, s101
    s_cbranch_scc1 Lqd_61
    s_branch Lwo_66
Ldn_67:
Lqc_60:
    v_max3_u32 v44, v46, v47, v48
    v_max3_u32 v44, v44, v49, v50
    v_max3_u32 v44, v44, v51, v52
    v_max3_u32 v44, v44, v53, v54
    v_max_u32 v44, v44, v55
    v_cmp_eq_u32 vcc, -1, v44
    s_nop 0
    s_cbranch_vccz Ldn_59
    s_add_u32 s42, s42, 1
    s_cmp_lt_u32 s42, s43
    s_cbranch_scc1 Lwq_58
    s_mov_b32 s43, 0
Ldn_59:
    s_call_b64 s[78:79], S_E
    s_branch Lgo_62
Lqd_61:
    s_call_b64 s[78:79], S_E2
Lgo_62:
    s_lshl_b32 s44, s7, 7
    s_add_u32 s44, s44, s5
    s_lshl_b32 s56, s44, 11
    s_add_u32 s56, s56, 2490368
    s_lshl_b32 s57, s44, 6
    s_add_u32 s57, s57, 3538944
    v_and_b32 v44, 0x30, v2
    buffer_load_dwordx4 v[48:51], v2, s[24:27], s56 offen sc1
    buffer_load_dwordx4 v[52:55], v2, s[24:27], s56 offen offset:1024 sc1
    buffer_load_dwordx2 v[46:47], v44, s[24:27], s57 offen sc1
    s_call_b64 s[78:79], S_kB
    s_lshl_b32 s44, s3, 10
    s_add_u32 s44, s44, 157952
    v_add_u32 v44, s44, v2
    ds_write_b128 v44, v[12:15]
    v_readfirstlane_b32 s90, v7
L_dno4a:
    s_add_u32 s39, s38, 0
    s_add_u32 m0, s37, 73728
    s_waitcnt vmcnt(15)
    buffer_load_dwordx4 v0, s[16:19], s39 offen offset:0 nt lds
    s_waitcnt vmcnt(15)
    buffer_load_dwordx4 v0, s[16:19], s39 offen offset:1024 nt lds
    s_waitcnt vmcnt(15)
    buffer_load_dwordx4 v0, s[16:19], s39 offen offset:2048 nt lds
    s_waitcnt vmcnt(15)
    buffer_load_dwordx4 v0, s[16:19], s39 offen offset:3072 nt lds
    s_add_u32 s39, s38, 16384
    s_add_u32 m0, s37, 77824
    s_waitcnt vmcnt(15)
    buffer_load_dwordx4 v0, s[16:19], s39 offen offset:0 nt lds
    s_waitcnt vmcnt(15)
    buffer_load_dwordx4 v0, s[16:19], s39 offen offset:1024 nt lds
    s_waitcnt vmcnt(15)
    buffer_load_dwordx4 v0, s[16:19], s39 offen offset:2048 nt lds
    s_waitcnt vmcnt(15)
    buffer_load_dwordx4 v0, s[16:19], s39 offen offset:3072 nt lds
    s_lshl_b32 s48, s3, 10
    s_add_u32 s48, s48, 0
    s_mov_b32 s59, 0
    s_lshl_b32 s49, s7, 2
    s_mov_b32 s58, 156800
    s_mov_b32 s54, 155776
    s_mov_b32 s47, 0
    s_mov_b32 s55, 0
    s_mov_b32 s42, 0
    s_add_u32 s101, s101, 1
Lwo_74:
    s_add_u32 s45, s55, 8
    s_min_u32 s45, s45, 15
    s_nop 1
    s_getreg_b32 s44, hwreg(HW_REG_IB_STS)
    s_and_b32 s44, s44, 0xc0000f
    s_cmp_le_u32 s44, s45
    s_cbranch_scc1 Ldn_75
    s_cmp_ge_u32 s41, s47
    s_cbranch_scc1 Lwo_74
    s_min_u32 s46, s44, s41
    s_mul_i32 s46, s46, 3
    s_add_u32 s44, s44, s46
    s_cmp_gt_u32 s44, 4
    s_cbranch_scc1 Lwo_74
    s_mov_b32 exec_hi, 0
    buffer_load_dword v5, v3, s[16:19], s40 offen
    s_mov_b64 exec, -1
    s_add_u32 s41, s41, 1
    s_add_u32 s55, s55, 1
    s_add_u32 s100, s100, 1
    s_add_u32 s44, s40, 16384
    s_and_b32 s44, s44, 0x3fffff
    s_andn2_b32 s40, s40, 0x3fffff
    s_or_b32 s40, s40, s44
    s_branch Lwo_74
Ldn_75:
    s_branch Lqc_71
Lwq_69:
    v_and_b32 v44, 0x30, v2
    buffer_load_dwordx4 v[48:51], v2, s[24:27], s56 offen sc1
    buffer_load_dwordx4 v[52:55], v2, s[24:27], s56 offen offset:1024 sc1
    buffer_load_dwordx2 v[46:47], v44, s[24:27], s57 offen sc1
    s_add_u32 s55, s55, 3
    s_mov_b32 s100, 0
Lwo_77:
    ds_read_b32 v45, v4 offset:10384
    s_add_u32 s45, s100, 0
    s_min_u32 s45, s45, 15
    s_nop 1
    s_getreg_b32 s44, hwreg(HW_REG_IB_STS)
    s_and_b32 s44, s44, 0xc0000f
    s_cmp_le_u32 s44, s45
    s_cbranch_scc1 Ldn_78
    s_cmp_ge_u32 s41, s47
    s_cbranch_scc1 Lsk_79
    s_sub_u32 s46, s44, s100
    s_min_u32 s46, s46, 3
    s_sub_u32 s44, s44, s46
    s_min_u32 s46, s44, s41
    s_mul_i32 s46, s46, 3
    s_add_u32 s44, s44, s46
    s_cmp_gt_u32 s44, 4
    s_cbranch_scc1 Lsk_79
    s_mov_b32 exec_hi, 0
    buffer_load_dword v5, v3, s[16:19], s40 offen
    s_mov_b64 exec, -1
    s_add_u32 s41, s41, 1
    s_add_u32 s55, s55, 1
    s_add_u32 s100, s100, 1
    s_add_u32 s44, s40, 16384
    s_and_b32 s44, s44, 0x3fffff
    s_andn2_b32 s40, s40, 0x3fffff
    s_or_b32 s40, s40, s44
Lsk_79:
    s_waitcnt lgkmcnt(0)
    v_readfirstlane_b32 s44, v45
    s_nop 0
    s_cmp_ge_u32 s44, s101
    s_cbranch_scc1 Lqd_72
    s_branch Lwo_77
Ldn_78:
Lqc_71:
    v_max3_u32 v44, v46, v47, v48
    v_max3_u32 v44, v44, v49, v50
    v_max3_u32 v44, v44, v51, v52
    v_max3_u32 v44, v44, v53, v54
    v_max_u32 v44, v44, v55
    v_cmp_eq_u32 vcc, -1, v44
    s_nop 0
    s_cbranch_vccz Ldn_70
    s_add_u32 s42, s42, 1
    s_cmp_lt_u32 s42, s43
    s_cbranch_scc1 Lwq_69
    s_mov_b32 s43, 0
Ldn_70:
    s_call_b64 s[78:79], S_E
    s_branch Lgo_73
Lqd_72:
    s_call_b64 s[78:79], S_E2
Lgo_73:
    s_call_b64 s[78:79], S_kA
    s_add_u32 s39, s38, 32768
    s_waitcnt vmcnt(15)
    buffer_load_dwordx4 a[224:227], v0, s[16:19], s39 offen offset:0 nt
    s_waitcnt vmcnt(15)
    buffer_load_dwordx4 a[228:231], v0, s[16:19], s39 offen offset:1024 nt
    s_waitcnt vmcnt(15)
    buffer_load_dwordx4 a[232:235], v0, s[16:19], s39 offen offset:2048 nt
    s_waitcnt vmcnt(15)
    buffer_load_dwordx4 a[236:239], v0, s[16:19], s39 offen offset:3072 nt
    s_add_u32 s39, s38, 49152
    s_waitcnt vmcnt(15)
    buffer_load_dwordx4 a[240:243], v0, s[16:19], s39 offen offset:0 nt
    s_waitcnt vmcnt(15)
    buffer_load_dwordx4 a[244:247], v0, s[16:19], s39 offen offset:1024 nt
    s_waitcnt vmcnt(15)
    buffer_load_dwordx4 a[248:251], v0, s[16:19], s39 offen offset:2048 nt
    s_waitcnt vmcnt(15)
    buffer_load_dwordx4 a[252:255], v0, s[16:19], s39 offen offset:3072 nt
    s_call_b64 s[78:79], S_vA
    s_call_b64 s[78:79], S_vA2
    s_call_b64 s[78:79], S_vA3
    s_add_u32 s39, s38, 65536
    s_waitcnt vmcnt(15)
    buffer_load_dwordx4 v[64:67], v0, s[16:19], s39 offen offset:0 nt
    s_waitcnt vmcnt(15)
    buffer_load_dwordx4 v[68:71], v0, s[16:19], s39 offen offset:1024 nt
    s_waitcnt vmcnt(15)
    buffer_load_dwordx4 v[72:75], v0, s[16:19], s39 offen offset:2048 nt
    s_waitcnt vmcnt(15)
    buffer_load_dwordx4 v[76:79], v0, s[16:19], s39 offen offset:3072 nt
    s_add_u32 s39, s38, 81920
    s_waitcnt vmcnt(15)
    buffer_load_dwordx4 v[80:83], v0, s[16:19], s39 offen offset:0 nt
    s_waitcnt vmcnt(15)
    buffer_load_dwordx4 v[84:87], v0, s[16:19], s39 offen offset:1024 nt
    s_waitcnt vmcnt(15)
    buffer_load_dwordx4 v[88:91], v0, s[16:19], s39 offen offset:2048 nt
    s_waitcnt vmcnt(15)
    buffer_load_dwordx4 v[92:95], v0, s[16:19], s39 offen offset:3072 nt
    s_cmp_eq_u32 s7, 0
    s_cbranch_scc1 L_dno4b
    s_lshl_b32 s48, s3, 10
    s_add_u32 s48, s48, 4096
    s_mov_b32 s59, 3
    s_lshl_b32 s49, s7, 2
    s_sub_u32 s49, s49, 1
    s_mov_b32 s58, 157312
    s_mov_b32 s54, 156544
    s_lshl_b32 s44, s3, 10
    s_add_u32 s44, s44, 157952
    v_add_u32 v44, s44, v2
    ds_read_b128 v[12:15], v44
    v_mov_b32 v7, s90
    s_waitcnt lgkmcnt(0)
    s_call_b64 s[78:79], S_vB
    s_call_b64 s[78:79], S_vB3
L_dno4b:
    s_lshl_b32 s48, s3, 10
    s_add_u32 s48, s48, 0
    s_mov_b32 s59, 1
    s_lshl_b32 s49, s7, 2
    s_add_u32 s49, s49, 1
    s_mov_b32 s58, 157312
    s_mov_b32 s54, 156032
    s_lshl_b32 s44, s7, 7
    s_add_u32 s44, s44, s5
    s_lshl_b32 s56, s44, 11
    s_add_u32 s56, s56, 2555904
    s_lshl_b32 s57, s44, 6
    s_add_u32 s57, s57, 3540992
    s_cmp_ge_u32 s6, 4
    s_cbranch_scc1 Lnx_80
    s_add_u32 s39, s38, s61
    s_add_u32 m0, s37, 81920
    s_nop 0
    buffer_load_dwordx4 v0, s[16:19], s39 offen nt lds
Lnx_80:
    s_add_u32 s39, s38, 98304
    s_waitcnt vmcnt(5)
    buffer_load_dwordx4 v[96:99], v0, s[16:19], s39 offen offset:0 nt
    s_waitcnt vmcnt(5)
    buffer_load_dwordx4 v[100:103], v0, s[16:19], s39 offen offset:1024 nt
    s_waitcnt vmcnt(5)
    buffer_load_dwordx4 v[104:107], v0, s[16:19], s39 offen offset:2048 nt
    s_waitcnt vmcnt(5)
    buffer_load_dwordx4 v[108:111], v0, s[16:19], s39 offen offset:3072 nt
    s_barrier
    s_add_u32 s39, s38, 114688
    s_waitcnt vmcnt(5)
    buffer_load_dwordx4 v[112:115], v0, s[16:19], s39 offen offset:0 nt
    s_waitcnt vmcnt(5)
    buffer_load_dwordx4 v[116:119], v0, s[16:19], s39 offen offset:1024 nt
    s_waitcnt vmcnt(5)
    buffer_load_dwordx4 v[120:123], v0, s[16:19], s39 offen offset:2048 nt
    s_waitcnt vmcnt(5)
    buffer_load_dwordx4 v[124:127], v0, s[16:19], s39 offen offset:3072 nt
    s_add_u32 s39, s38, 131072
    s_waitcnt vmcnt(5)
    buffer_load_dwordx4 v[128:131], v0, s[16:19], s39 offen offset:0 nt
    s_waitcnt vmcnt(5)
    buffer_load_dwordx4 v[132:135], v0, s[16:19], s39 offen offset:1024 nt
    s_waitcnt vmcnt(5)
    buffer_load_dwordx4 v[136:139], v0, s[16:19], s39 offen offset:2048 nt
    s_waitcnt vmcnt(5)
    buffer_load_dwordx4 v[140:143], v0, s[16:19], s39 offen offset:3072 nt
    s_cmp_ge_u32 s6, 4
    s_cbranch_scc1 Lnx_81
    s_add_u32 s39, s38, s61
    s_add_u32 m0, s37, 118784
    s_nop 0
    buffer_load_dwordx4 v2, s[20:23], s39 offen nt lds
Lnx_81:
    s_add_u32 s39, s38, 32768
    s_waitcnt vmcnt(5)
    buffer_load_dwordx4 v[144:147], v1, s[20:23], s39 offen offset:0 nt
    s_waitcnt vmcnt(5)
    buffer_load_dwordx4 v[148:151], v1, s[20:23], s39 offen offset:128 nt
    s_waitcnt vmcnt(5)
    buffer_load_dwordx4 v[152:155], v1, s[20:23], s39 offen offset:256 nt
    s_waitcnt vmcnt(5)
    buffer_load_dwordx4 v[156:159], v1, s[20:23], s39 offen offset:384 nt
    s_barrier
    s_add_u32 s39, s38, 49152
    s_waitcnt vmcnt(5)
    buffer_load_dwordx4 v[160:163], v1, s[20:23], s39 offen offset:0 nt
    s_waitcnt vmcnt(5)
    buffer_load_dwordx4 v[164:167], v1, s[20:23], s39 offen offset:128 nt
    s_waitcnt vmcnt(5)
    buffer_load_dwordx4 v[168:171], v1, s[20:23], s39 offen offset:256 nt
    s_waitcnt vmcnt(5)
    buffer_load_dwordx4 v[172:175], v1, s[20:23], s39 offen offset:384 nt
    s_add_u32 s39, s38, 0
    s_add_u32 m0, s37, 110592
    s_waitcnt vmcnt(5)
    buffer_load_dwordx4 v1, s[20:23], s39 offen offset:0 nt lds
    s_add_u32 m0, s37, 111488
    s_waitcnt vmcnt(5)
    buffer_load_dwordx4 v1, s[20:23], s39 offen offset:128 nt lds
    s_add_u32 m0, s37, 112384
    s_waitcnt vmcnt(5)
    buffer_load_dwordx4 v1, s[20:23], s39 offen offset:256 nt lds
    s_add_u32 m0, s37, 113280
    s_waitcnt vmcnt(5)
    buffer_load_dwordx4 v1, s[20:23], s39 offen offset:384 nt lds
    s_add_u32 s39, s38, 65536
    s_waitcnt vmcnt(5)
    buffer_load_dwordx4 v[176:179], v1, s[20:23], s39 offen offset:0 nt
    s_waitcnt vmcnt(5)
    buffer_load_dwordx4 v[180:183], v1, s[20:23], s39 offen offset:128 nt
    s_waitcnt vmcnt(5)
    buffer_load_dwordx4 v[184:187], v1, s[20:23], s39 offen offset:256 nt
    s_waitcnt vmcnt(5)
    buffer_load_dwordx4 v[188:191], v1, s[20:23], s39 offen offset:384 nt
    s_cmp_lg_u32 s7, 0
    s_cbranch_scc1 Lfo_82
    s_lshl_b32 s45, s5, 11
    s_add_u32 s45, s45, 3637248
    buffer_load_dwordx4 v[20:23], v2, s[24:27], s45 offen sc1
    buffer_load_dwordx4 v[24:27], v2, s[24:27], s45 offen offset:1024 sc1
Lfo_82:
    s_add_u32 s39, s38, 16384
    s_add_u32 m0, s37, 114688
    s_waitcnt vmcnt(5)
    buffer_load_dwordx4 v1, s[20:23], s39 offen offset:0 nt lds
    s_add_u32 m0, s37, 115584
    s_waitcnt vmcnt(5)
    buffer_load_dwordx4 v1, s[20:23], s39 offen offset:128 nt lds
    s_add_u32 m0, s37, 116480
    s_waitcnt vmcnt(5)
    buffer_load_dwordx4 v1, s[20:23], s39 offen offset:256 nt lds
    s_add_u32 m0, s37, 117376
    s_waitcnt vmcnt(5)
    buffer_load_dwordx4 v1, s[20:23], s39 offen offset:384 nt lds
    s_barrier
    s_add_u32 s39, s38, 81920
    s_waitcnt vmcnt(5)
    buffer_load_dwordx4 v[192:195], v1, s[20:23], s39 offen offset:0 nt
    s_waitcnt vmcnt(5)
    buffer_load_dwordx4 v[196:199], v1, s[20:23], s39 offen offset:128 nt
    s_waitcnt vmcnt(5)
    buffer_load_dwordx4 v[200:203], v1, s[20:23], s39 offen offset:256 nt
    s_waitcnt vmcnt(5)
    buffer_load_dwordx4 v[204:207], v1, s[20:23], s39 offen offset:384 nt
    s_cmp_lg_u32 s7, 0
    s_cbranch_scc1 Lfo_83
    s_mov_b32 s42, 0
    s_waitcnt vmcnt(8)
    s_branch Lcc_86
Lcs_84:
    s_lshl_b32 s45, s5, 11
    s_add_u32 s45, s45, 3637248
    buffer_load_dwordx4 v[20:23], v2, s[24:27], s45 offen sc1
    buffer_load_dwordx4 v[24:27], v2, s[24:27], s45 offen offset:1024 sc1
    s_waitcnt vmcnt(0)
Lcc_86:
    v_max3_u32 v44, v20, v21, v22
    v_max3_u32 v44, v44, v23, v24
    v_max3_u32 v44, v44, v25, v26
    v_max_u32 v44, v44, v27
    v_cmp_eq_u32 vcc, -1, v44
    s_nop 0
    s_cbranch_vccz Lco_85
    s_add_u32 s42, s42, 1
    s_cmp_lt_u32 s42, s43
    s_cbranch_scc1 Lcs_84
    s_mov_b32 s43, 0
Lco_85:
    v_pk_add_f32 v[20:21], v[20:21], v[24:25]
    v_pk_add_f32 v[22:23], v[22:23], v[26:27]
    s_nop 1
    v_permlane32_swap_b32 v20, v22
    v_permlane32_swap_b32 v21, v23
    v_add_f32 v20, v20, v22
    v_add_f32 v21, v21, v23
    v_lshrrev_b32 v44, 1, v2
    v_add_u32 v44, v44, v4
    ds_write_b64 v44, v[20:21] offset:9856
Lfo_83:
    v_and_b32 v44, 0x30, v2
    buffer_load_dwordx4 v[48:51], v2, s[24:27], s56 offen sc1
    buffer_load_dwordx4 v[52:55], v2, s[24:27], s56 offen offset:1024 sc1
    buffer_load_dwordx2 v[46:47], v44, s[24:27], s57 offen sc1
    s_add_u32 s39, s38, 98304
    s_waitcnt vmcnt(8)
    buffer_load_dwordx4 v[208:211], v1, s[20:23], s39 offen offset:0 nt
    s_waitcnt vmcnt(8)
    buffer_load_dwordx4 v[212:215], v1, s[20:23], s39 offen offset:128 nt
    s_waitcnt vmcnt(8)
    buffer_load_dwordx4 v[216:219], v1, s[20:23], s39 offen offset:256 nt
    s_waitcnt vmcnt(8)
    buffer_load_dwordx4 v[220:223], v1, s[20:23], s39 offen offset:384 nt
    s_add_u32 s39, s38, 114688
    s_waitcnt vmcnt(15)
    buffer_load_dwordx4 v[224:227], v1, s[20:23], s39 offen offset:0 nt
    s_waitcnt vmcnt(15)
    buffer_load_dwordx4 v[228:231], v1, s[20:23], s39 offen offset:128 nt
    s_waitcnt vmcnt(15)
    buffer_load_dwordx4 v[232:235], v1, s[20:23], s39 offen offset:256 nt
    s_waitcnt vmcnt(15)
    buffer_load_dwordx4 v[236:239], v1, s[20:23], s39 offen offset:384 nt
    s_add_u32 s39, s38, 131072
    s_waitcnt vmcnt(15)
    buffer_load_dwordx4 v[240:243], v1, s[20:23], s39 offen offset:0 nt
    s_waitcnt vmcnt(15)
    buffer_load_dwordx4 v[244:247], v1, s[20:23], s39 offen offset:128 nt
    s_waitcnt vmcnt(15)
    buffer_load_dwordx4 v[248:251], v1, s[20:23], s39 offen offset:256 nt
    s_waitcnt vmcnt(15)
    buffer_load_dwordx4 v[252:255], v1, s[20:23], s39 offen offset:384 nt
    s_add_u32 s40, s38, 33554432
    s_mov_b32 s41, 0
    s_mov_b32 s55, 0
    s_cmp_eq_u32 s7, 3
    s_cselect_b32 s47, 0, 0
    s_mov_b32 s42, 0
    s_add_u32 s101, s101, 1
Lwo_92:
    s_add_u32 s45, s55, 12
    s_min_u32 s45, s45, 15
    s_nop 1
    s_getreg_b32 s44, hwreg(HW_REG_IB_STS)
    s_and_b32 s44, s44, 0xc0000f
    s_cmp_le_u32 s44, s45
    s_cbranch_scc1 Ldn_93
    s_cmp_ge_u32 s41, s47
    s_cbranch_scc1 Lwo_92
    s_min_u32 s46, s44, s41
    s_mul_i32 s46, s46, 3
    s_add_u32 s44, s44, s46
    s_cmp_gt_u32 s44, 4
    s_cbranch_scc1 Lwo_92
    s_mov_b32 exec_hi, 0
    buffer_load_dword v5, v3, s[8:11], s40 offen
    s_mov_b64 exec, -1
    s_add_u32 s41, s41, 1
    s_add_u32 s55, s55, 1
    s_add_u32 s100, s100, 1
    s_add_u32 s44, s40, 16384
    s_and_b32 s44, s44, 0x3fffff
    s_andn2_b32 s40, s40, 0x3fffff
    s_or_b32 s40, s40, s44
    s_branch Lwo_92
Ldn_93:
    s_branch Lqc_89
Lwq_87:
    v_and_b32 v44, 0x30, v2
    buffer_load_dwordx4 v[48:51], v2, s[24:27], s56 offen sc1
    buffer_load_dwordx4 v[52:55], v2, s[24:27], s56 offen offset:1024 sc1
    buffer_load_dwordx2 v[46:47], v44, s[24:27], s57 offen sc1
    s_add_u32 s55, s55, 3
    s_mov_b32 s100, 0
Lwo_95:
    ds_read_b32 v45, v4 offset:10384
    s_add_u32 s45, s100, 0
    s_min_u32 s45, s45, 15
    s_nop 1
    s_getreg_b32 s44, hwreg(HW_REG_IB_STS)
    s_and_b32 s44, s44, 0xc0000f
    s_cmp_le_u32 s44, s45
    s_cbranch_scc1 Ldn_96
    s_cmp_ge_u32 s41, s47
    s_cbranch_scc1 Lsk_97
    s_sub_u32 s46, s44, s100
    s_min_u32 s46, s46, 3
    s_sub_u32 s44, s44, s46
    s_min_u32 s46, s44, s41
    s_mul_i32 s46, s46, 3
    s_add_u32 s44, s44, s46
    s_cmp_gt_u32 s44, 4
    s_cbranch_scc1 Lsk_97
    s_mov_b32 exec_hi, 0
    buffer_load_dword v5, v3, s[8:11], s40 offen
    s_mov_b64 exec, -1
    s_add_u32 s41, s41, 1
    s_add_u32 s55, s55, 1
    s_add_u32 s100, s100, 1
    s_add_u32 s44, s40, 16384
    s_and_b32 s44, s44, 0x3fffff
    s_andn2_b32 s40, s40, 0x3fffff
    s_or_b32 s40, s40, s44
Lsk_97:
    s_waitcnt lgkmcnt(0)
    v_readfirstlane_b32 s44, v45
    s_nop 0
    s_cmp_ge_u32 s44, s101
    s_cbranch_scc1 Lqd_90
    s_branch Lwo_95
Ldn_96:
Lqc_89:
    v_max3_u32 v44, v46, v47, v48
    v_max3_u32 v44, v44, v49, v50
    v_max3_u32 v44, v44, v51, v52
    v_max3_u32 v44, v44, v53, v54
    v_max_u32 v44, v44, v55
    v_cmp_eq_u32 vcc, -1, v44
    s_nop 0
    s_cbranch_vccz Ldn_88
    s_add_u32 s42, s42, 1
    s_cmp_lt_u32 s42, s43
    s_cbranch_scc1 Lwq_87
    s_mov_b32 s43, 0
Ldn_88:
    s_call_b64 s[78:79], S_E
    s_branch Lgo_91
Lqd_90:
    s_call_b64 s[78:79], S_E2
Lgo_91:
    s_call_b64 s[78:79], S_kB
Lwo_98:
    s_add_u32 s45, s55, 8
    s_min_u32 s45, s45, 15
    s_nop 1
    s_getreg_b32 s44, hwreg(HW_REG_IB_STS)
    s_and_b32 s44, s44, 0xc0000f
    s_cmp_le_u32 s44, s45
    s_cbranch_scc1 Ldn_99
    s_cmp_ge_u32 s41, s47
    s_cbranch_scc1 Lwo_98
    s_min_u32 s46, s44, s41
    s_mul_i32 s46, s46, 3
    s_add_u32 s44, s44, s46
    s_cmp_gt_u32 s44, 4
    s_cbranch_scc1 Lwo_98
    s_mov_b32 exec_hi, 0
    buffer_load_dword v5, v3, s[8:11], s40 offen
    s_mov_b64 exec, -1
    s_add_u32 s41, s41, 1
    s_add_u32 s55, s55, 1
    s_add_u32 s100, s100, 1
    s_add_u32 s44, s40, 16384
    s_and_b32 s44, s44, 0x3fffff
    s_andn2_b32 s40, s40, 0x3fffff
    s_or_b32 s40, s40, s44
    s_branch Lwo_98
Ldn_99:
    s_cmp_ge_u32 s41, s47
    s_cbranch_scc1 Ltu_101
    s_getreg_b32 s44, hwreg(HW_REG_IB_STS)
    s_and_b32 s44, s44, 0xc0000f
    s_min_u32 s46, s44, s41
    s_mul_i32 s46, s46, 3
    s_add_u32 s44, s44, s46
    s_cmp_gt_u32 s44, 7
    s_cbranch_scc1 Ltu_101
    s_mov_b32 exec_hi, 0
    buffer_load_dword v5, v3, s[8:11], s40 offen
    s_mov_b64 exec, -1
    s_add_u32 s41, s41, 1
    s_add_u32 s55, s55, 1
    s_add_u32 s100, s100, 1
    s_add_u32 s44, s40, 16384
    s_and_b32 s44, s44, 0x3fffff
    s_andn2_b32 s40, s40, 0x3fffff
    s_or_b32 s40, s40, s44
Ltu_101:
    s_call_b64 s[78:79], S_vB
Lwo_102:
    s_add_u32 s45, s55, 0
    s_min_u32 s45, s45, 15
    s_nop 1
    s_getreg_b32 s44, hwreg(HW_REG_IB_STS)
    s_and_b32 s44, s44, 0xc0000f
    s_cmp_le_u32 s44, s45
    s_cbranch_scc1 Ldn_103
    s_cmp_ge_u32 s41, s47
    s_cbranch_scc1 Lwo_102
    s_min_u32 s46, s44, s41
    s_mul_i32 s46, s46, 3
    s_add_u32 s44, s44, s46
    s_cmp_gt_u32 s44, 4
    s_cbranch_scc1 Lwo_102
    s_mov_b32 exec_hi, 0
    buffer_load_dword v5, v3, s[8:11], s40 offen
    s_mov_b64 exec, -1
    s_add_u32 s41, s41, 1
    s_add_u32 s55, s55, 1
    s_add_u32 s100, s100, 1
    s_add_u32 s44, s40, 16384
    s_and_b32 s44, s44, 0x3fffff
    s_andn2_b32 s40, s40, 0x3fffff
    s_or_b32 s40, s40, s44
    s_branch Lwo_102
Ldn_103:
    s_cmp_ge_u32 s41, s47
    s_cbranch_scc1 Ltu_105
    s_getreg_b32 s44, hwreg(HW_REG_IB_STS)
    s_and_b32 s44, s44, 0xc0000f
    s_min_u32 s46, s44, s41
    s_mul_i32 s46, s46, 3
    s_add_u32 s44, s44, s46
    s_cmp_gt_u32 s44, 7
    s_cbranch_scc1 Ltu_105
    s_mov_b32 exec_hi, 0
    buffer_load_dword v5, v3, s[8:11], s40 offen
    s_mov_b64 exec, -1
    s_add_u32 s41, s41, 1
    s_add_u32 s55, s55, 1
    s_add_u32 s100, s100, 1
    s_add_u32 s44, s40, 16384
    s_and_b32 s44, s44, 0x3fffff
    s_andn2_b32 s40, s40, 0x3fffff
    s_or_b32 s40, s40, s44
Ltu_105:
    s_call_b64 s[78:79], S_vB3
    s_mov_b32 s42, 0
Lh_106:
    ds_read_b32 v44, v4 offset:10388
    s_waitcnt lgkmcnt(0)
    v_readfirstlane_b32 s44, v44
    s_nop 0
    s_cmp_eq_u32 s44, s49
    s_cbranch_scc1 Lh_107
    s_add_u32 s42, s42, 1
    s_cmp_lt_u32 s42, s43
    s_cbranch_scc1 Lh_106
    s_mov_b32 s43, 0
Lh_107:
    s_cmp_eq_u32 s7, 3
    s_cselect_b32 s47, 0, 7
    s_lshl_b32 s48, s3, 10
    s_add_u32 s48, s48, 4096
    s_mov_b32 s59, 2
    s_lshl_b32 s49, s7, 2
    s_add_u32 s49, s49, 2
    s_mov_b32 s58, 156800
    s_mov_b32 s54, 156288
    s_lshl_b32 s44, s7, 7
    s_add_u32 s44, s44, s5
    s_lshl_b32 s56, s44, 11
    s_add_u32 s56, s56, 2621440
    s_lshl_b32 s57, s44, 6
    s_add_u32 s57, s57, 3543040
    s_mov_b32 s42, 0
    s_add_u32 s101, s101, 1
Lwq_108:
    s_cmp_lt_u32 s41, s47
    s_cbranch_scc1 Lpl_113
    s_cmp_lt_u32 s3, 1
    s_cbranch_scc1 Lfw_114
    ds_read_b32 v45, v4 offset:10384
    s_waitcnt lgkmcnt(0)
    v_readfirstlane_b32 s44, v45
    s_nop 0
    s_cmp_ge_u32 s44, s101
    s_cbranch_scc1 Lqd_111
    s_add_u32 s42, s42, 1
    s_cmp_lt_u32 s42, s43
    s_cbranch_scc1 Lwq_108
    s_mov_b32 s43, 0
    s_branch Lqd_111
Lfw_114:
    v_and_b32 v44, 0x30, v2
    buffer_load_dwordx4 v[48:51], v2, s[24:27], s56 offen sc1
    buffer_load_dwordx4 v[52:55], v2, s[24:27], s56 offen offset:1024 sc1
    buffer_load_dwordx2 v[46:47], v44, s[24:27], s57 offen sc1
    s_waitcnt vmcnt(0)
    s_branch Lqc_110
Lpl_113:
    v_and_b32 v44, 0x30, v2
    buffer_load_dwordx4 v[48:51], v2, s[24:27], s56 offen sc1
    buffer_load_dwordx4 v[52:55], v2, s[24:27], s56 offen offset:1024 sc1
    buffer_load_dwordx2 v[46:47], v44, s[24:27], s57 offen sc1
    s_add_u32 s55, s55, 3
    s_mov_b32 s100, 0
Lwo_115:
    ds_read_b32 v45, v4 offset:10384
    s_add_u32 s45, s100, 0
    s_min_u32 s45, s45, 15
    s_nop 1
    s_getreg_b32 s44, hwreg(HW_REG_IB_STS)
    s_and_b32 s44, s44, 0xc0000f
    s_cmp_le_u32 s44, s45
    s_cbranch_scc1 Ldn_116
    s_cmp_ge_u32 s41, s47
    s_cbranch_scc1 Lsk_117
    s_sub_u32 s46, s44, s100
    s_min_u32 s46, s46, 3
    s_sub_u32 s44, s44, s46
    s_min_u32 s46, s44, s41
    s_mul_i32 s46, s46, 3
    s_add_u32 s44, s44, s46
    s_cmp_gt_u32 s44, 4
    s_cbranch_scc1 Lsk_117
    s_mov_b32 exec_hi, 0
    buffer_load_dword v5, v3, s[8:11], s40 offen
    s_mov_b64 exec, -1
    s_add_u32 s41, s41, 1
    s_add_u32 s55, s55, 1
    s_add_u32 s100, s100, 1
    s_add_u32 s44, s40, 16384
    s_and_b32 s44, s44, 0x3fffff
    s_andn2_b32 s40, s40, 0x3fffff
    s_or_b32 s40, s40, s44
Lsk_117:
    s_waitcnt lgkmcnt(0)
    v_readfirstlane_b32 s44, v45
    s_nop 0
    s_cmp_ge_u32 s44, s101
    s_cbranch_scc1 Lqd_111
    s_branch Lwo_115
Ldn_116:
Lqc_110:
    v_max3_u32 v44, v46, v47, v48
    v_max3_u32 v44, v44, v49, v50
    v_max3_u32 v44, v44, v51, v52
    v_max3_u32 v44, v44, v53, v54
    v_max_u32 v44, v44, v55
    v_cmp_eq_u32 vcc, -1, v44
    s_nop 0
    s_cbranch_vccz Ldn_109
    s_add_u32 s42, s42, 1
    s_cmp_lt_u32 s42, s43
    s_cbranch_scc1 Lwq_108
    s_mov_b32 s43, 0
Ldn_109:
    s_call_b64 s[78:79], S_E
    s_branch Lgo_112
Lqd_111:
    s_call_b64 s[78:79], S_E2
Lgo_112:
    s_cmp_ge_u32 s41, s47
    s_cbranch_scc1 Ltu_118
    s_getreg_b32 s44, hwreg(HW_REG_IB_STS)
    s_and_b32 s44, s44, 0xc0000f
    s_min_u32 s46, s44, s41
    s_mul_i32 s46, s46, 3
    s_add_u32 s44, s44, s46
    s_cmp_gt_u32 s44, 7
    s_cbranch_scc1 Ltu_118
    s_mov_b32 exec_hi, 0
    buffer_load_dword v5, v3, s[8:11], s40 offen
    s_mov_b64 exec, -1
    s_add_u32 s41, s41, 1
    s_add_u32 s55, s55, 1
    s_add_u32 s100, s100, 1
    s_add_u32 s44, s40, 16384
    s_and_b32 s44, s44, 0x3fffff
    s_andn2_b32 s40, s40, 0x3fffff
    s_or_b32 s40, s40, s44
Ltu_118:
    s_call_b64 s[78:79], S_kA
    s_cmp_eq_u32 s7, 3
    s_cbranch_scc1 Lne_119
    s_add_u32 s39, s38, 33554432
    s_add_u32 m0, s37, 0
    s_nop 0
    buffer_load_dwordx4 v0, s[8:11], s39 offen offset:0 nt lds
    buffer_load_dwordx4 v0, s[8:11], s39 offen offset:1024 nt lds
    buffer_load_dwordx4 v0, s[8:11], s39 offen offset:2048 nt lds
    buffer_load_dwordx4 v0, s[8:11], s39 offen offset:3072 nt lds
    s_add_u32 s39, s38, 33570816
    s_add_u32 m0, s37, 4096
    s_nop 0
    buffer_load_dwordx4 v0, s[8:11], s39 offen offset:0 nt lds
    buffer_load_dwordx4 v0, s[8:11], s39 offen offset:1024 nt lds
    buffer_load_dwordx4 v0, s[8:11], s39 offen offset:2048 nt lds
    buffer_load_dwordx4 v0, s[8:11], s39 offen offset:3072 nt lds
Lne_119:
    s_call_b64 s[78:79], S_vA
    s_cmp_eq_u32 s7, 3
    s_cbranch_scc1 Lne_120
    s_add_u32 s39, s38, 33587200
    buffer_load_dwordx4 a[112:115], v1, s[12:15], s39 offen offset:0 nt
    buffer_load_dwordx4 a[116:119], v1, s[12:15], s39 offen offset:128 nt
    buffer_load_dwordx4 a[120:123], v1, s[12:15], s39 offen offset:256 nt
    buffer_load_dwordx4 a[124:127], v1, s[12:15], s39 offen offset:384 nt
Lne_120:
    s_call_b64 s[78:79], S_vA2
    s_cmp_eq_u32 s7, 3
    s_cbranch_scc1 Lne_121
    s_add_u32 s39, s38, 33603584
    buffer_load_dwordx4 a[128:131], v1, s[12:15], s39 offen offset:0 nt
    buffer_load_dwordx4 a[132:135], v1, s[12:15], s39 offen offset:128 nt
    buffer_load_dwordx4 a[136:139], v1, s[12:15], s39 offen offset:256 nt
    buffer_load_dwordx4 a[140:143], v1, s[12:15], s39 offen offset:384 nt
Lne_121:
    s_call_b64 s[78:79], S_vA3
    s_add_u32 s7, s7, 1
    s_branch L_dloop
L_dlast:
    s_mov_b32 s47, 0
    s_mov_b32 s42, 0
    s_add_u32 s101, s101, 1
Lwq_122:
    s_cmp_lt_u32 s41, s47
    s_cbranch_scc1 Lpl_127
    s_cmp_lt_u32 s3, 1
    s_cbranch_scc1 Lfw_128
    ds_read_b32 v45, v4 offset:10384
    s_waitcnt lgkmcnt(0)
    v_readfirstlane_b32 s44, v45
    s_nop 0
    s_cmp_ge_u32 s44, s101
    s_cbranch_scc1 Lqd_125
    s_add_u32 s42, s42, 1
    s_cmp_lt_u32 s42, s43
    s_cbranch_scc1 Lwq_122
    s_mov_b32 s43, 0
    s_branch Lqd_125
Lfw_128:
    v_and_b32 v44, 0x30, v2
    buffer_load_dwordx4 v[48:51], v2, s[24:27], s56 offen sc1
    buffer_load_dwordx4 v[52:55], v2, s[24:27], s56 offen offset:1024 sc1
    buffer_load_dwordx2 v[46:47], v44, s[24:27], s57 offen sc1
    s_waitcnt vmcnt(0)
    s_branch Lqc_124
Lpl_127:
    v_and_b32 v44, 0x30, v2
    buffer_load_dwordx4 v[48:51], v2, s[24:27], s56 offen sc1
    buffer_load_dwordx4 v[52:55], v2, s[24:27], s56 offen offset:1024 sc1
    buffer_load_dwordx2 v[46:47], v44, s[24:27], s57 offen sc1
    s_add_u32 s55, s55, 3
    s_mov_b32 s100, 0
Lwo_129:
    ds_read_b32 v45, v4 offset:10384
    s_add_u32 s45, s100, 0
    s_min_u32 s45, s45, 15
    s_nop 1
    s_getreg_b32 s44, hwreg(HW_REG_IB_STS)
    s_and_b32 s44, s44, 0xc0000f
    s_cmp_le_u32 s44, s45
    s_cbranch_scc1 Ldn_130
    s_cmp_ge_u32 s41, s47
    s_cbranch_scc1 Lsk_131
    s_sub_u32 s46, s44, s100
    s_min_u32 s46, s46, 3
    s_sub_u32 s44, s44, s46
    s_min_u32 s46, s44, s41
    s_mul_i32 s46, s46, 3
    s_add_u32 s44, s44, s46
    s_cmp_gt_u32 s44, 4
    s_cbranch_scc1 Lsk_131
    s_mov_b32 exec_hi, 0
    buffer_load_dword v5, v3, s[16:19], s40 offen
    s_mov_b64 exec, -1
    s_add_u32 s41, s41, 1
    s_add_u32 s55, s55, 1
    s_add_u32 s100, s100, 1
    s_add_u32 s44, s40, 16384
    s_and_b32 s44, s44, 0x3fffff
    s_andn2_b32 s40, s40, 0x3fffff
    s_or_b32 s40, s40, s44
Lsk_131:
    s_waitcnt lgkmcnt(0)
    v_readfirstlane_b32 s44, v45
    s_nop 0
    s_cmp_ge_u32 s44, s101
    s_cbranch_scc1 Lqd_125
    s_branch Lwo_129
Ldn_130:
Lqc_124:
    v_max3_u32 v44, v46, v47, v48
    v_max3_u32 v44, v44, v49, v50
    v_max3_u32 v44, v44, v51, v52
    v_max3_u32 v44, v44, v53, v54
    v_max_u32 v44, v44, v55
    v_cmp_eq_u32 vcc, -1, v44
    s_nop 0
    s_cbranch_vccz Ldn_123
    s_add_u32 s42, s42, 1
    s_cmp_lt_u32 s42, s43
    s_cbranch_scc1 Lwq_122
    s_mov_b32 s43, 0
Ldn_123:
    s_call_b64 s[78:79], S_E
    s_branch Lgo_126
Lqd_125:
    s_call_b64 s[78:79], S_E2
Lgo_126:
    s_call_b64 s[78:79], S_kB
    s_call_b64 s[78:79], S_vB
    s_call_b64 s[78:79], S_vB3
L_done:
L_exit:
    s_endpgm
S_E:
    v_lshrrev_b32 v44, 1, v2
    v_add_u32 v44, s58, v44
    ds_read_b64 v[26:27], v44
    v_add_f32_dpp v24, v46, v46 quad_perm:[1,0,3,2] row_mask:0xf bank_mask:0xf
    v_add_f32_dpp v25, v47, v47 quad_perm:[1,0,3,2] row_mask:0xf bank_mask:0xf
    v_pk_add_f32 v[20:21], v[48:49], v[52:53]
    v_pk_add_f32 v[22:23], v[50:51], v[54:55]
    v_add_f32_dpp v24, v24, v24 quad_perm:[2,3,0,1] row_mask:0xf bank_mask:0xf
    v_add_f32_dpp v25, v25, v25 quad_perm:[2,3,0,1] row_mask:0xf bank_mask:0xf
    v_and_b32 v28, 0xf0, v2
    v_mul_f32 v24, 0x3acccccd, v24
    v_mul_f32 v25, 0x3acccccd, v25
    v_fma_f32 v25, -v24, v24, v25
    v_max_f32 v25, 0, v25
    v_cvt_pk_bf16_f32 v44, v24, v25
    v_lshlrev_b32 v24, 16, v44
    v_and_b32 v25, 0xffff0000, v44
    v_add_f32 v25, 0x3727c5ac, v25
    v_cvt_pk_bf16_f32 v44, v25, v25
    v_lshlrev_b32 v25, 16, v44
    v_sqrt_f32 v25, v25
    v_permlane32_swap_b32 v20, v22
    v_permlane32_swap_b32 v21, v23
    v_add_f32 v20, v20, v22
    v_add_f32 v21, v21, v23
    v_cvt_pk_bf16_f32 v44, v25, v25
    v_lshlrev_b32 v25, 16, v44
    v_rcp_f32 v25, v25
    v_bfe_u32 v44, v2, 8, 1
    v_lshl_add_u32 v28, v44, 3, v28
    v_bfe_u32 v44, v2, 9, 1
    v_lshl_add_u32 v28, v44, 2, v28
    v_add_u32 v28, s54, v28
    v_mov_b32 v44, s101
    s_waitcnt lgkmcnt(0)
    v_fma_f32 v20, -v24, v26, v20
    v_fma_f32 v21, -v24, v27, v21
    v_mul_f32 v20, v20, v25
    v_mul_f32 v21, v21, v25
    v_cvt_pk_bf16_f32 v20, v20, v21
    ds_write_b32 v28, v20
    s_mov_b64 exec, 1
    ds_max_u32 v4, v44 offset:10384
    s_mov_b64 exec, -1
S_E2:
    v_and_b32 v44, 0xff, v0
    v_add_u32 v44, s54, v44
    ds_read_b128 v[40:43], v44
    s_setpc_b64 s[78:79]
S_kA:
    s_add_u32 s44, s37, 0
    v_add_u32 v45, s44, v2
    ds_read_b128 v[56:59], v45 offset:8192
    ds_read_b128 v[60:63], v45 offset:0
    v_mov_b32 v14, 0xff800000
    s_waitcnt lgkmcnt(2)
    v_cndmask_b32 v20, 0, v40, s[70:71]
    v_cndmask_b32 v21, 0, v41, s[70:71]
    v_cndmask_b32 v22, 0, v42, s[70:71]
    v_cndmask_b32 v23, 0, v43, s[70:71]
    v_cndmask_b32 v24, 0, v40, s[72:73]
    v_cndmask_b32 v25, 0, v41, s[72:73]
    v_cndmask_b32 v26, 0, v42, s[72:73]
    v_cndmask_b32 v27, 0, v43, s[72:73]
    v_cndmask_b32 v28, 0, v40, s[74:75]
    v_cndmask_b32 v29, 0, v41, s[74:75]
    v_cndmask_b32 v30, 0, v42, s[74:75]
    v_cndmask_b32 v31, 0, v43, s[74:75]
    v_cndmask_b32 v32, 0, v40, s[76:77]
    v_cndmask_b32 v33, 0, v41, s[76:77]
    v_cndmask_b32 v34, 0, v42, s[76:77]
    v_cndmask_b32 v35, 0, v43, s[76:77]
    s_waitcnt lgkmcnt(1)
    v_mfma_f32_16x16x32_bf16 v[16:19], v[40:43], v[56:59], 0
    ds_read_b128 v[56:59], v45 offset:1024
    v_mfma_f32_16x16x32_bf16 v[36:39], v[20:23], a[0:3], 0
    v_mfma_f32_16x16x32_bf16 v[36:39], v[24:27], a[4:7], v[36:39]
    v_mfma_f32_16x16x32_bf16 v[36:39], v[28:31], a[8:11], v[36:39]
    s_nop 3
    v_mov_b32_dpp v44, v16 quad_perm:[0,0,0,0] row_mask:0xf bank_mask:0xf
    v_add_f32_dpp v44, v17, v44 quad_perm:[1,1,1,1] row_mask:0xf bank_mask:0xf
    v_mfma_f32_16x16x32_bf16 v[36:39], v[32:35], a[12:15], v[36:39]
    v_add_f32_dpp v44, v18, v44 quad_perm:[2,2,2,2] row_mask:0xf bank_mask:0xf
    v_add_f32_dpp v44, v19, v44 quad_perm:[3,3,3,3] row_mask:0xf bank_mask:0xf
    s_nop 1
    v_mov_b32_dpp v44, v44 row_shl:4 row_mask:0x2 bank_mask:0xf
    s_nop 1
    v_mov_b32_dpp v44, v44 row_shl:8 row_mask:0x4 bank_mask:0xf
    s_nop 1
    v_mov_b32_dpp v44, v44 row_shl:12 row_mask:0x8 bank_mask:0xf
    v_cndmask_b32 v14, v14, v44, s[80:81]
    s_waitcnt lgkmcnt(1)
    v_mfma_f32_16x16x32_bf16 v[16:19], v[20:23], v[60:63], 0
    ds_read_b128 v[60:63], v45 offset:2048
    v_mfma_f32_16x16x32_bf16 v[40:43], v[20:23], a[16:19], 0
    v_mfma_f32_16x16x32_bf16 v[40:43], v[24:27], a[20:23], v[40:43]
    v_mov_b32_dpp v44, v36 quad_perm:[0,0,0,0] row_mask:0xf bank_mask:0xf
    v_add_f32_dpp v44, v37, v44 quad_perm:[1,1,1,1] row_mask:0xf bank_mask:0xf
    v_mfma_f32_16x16x32_bf16 v[40:43], v[28:31], a[24:27], v[40:43]
    v_add_f32_dpp v44, v38, v44 quad_perm:[2,2,2,2] row_mask:0xf bank_mask:0xf
    v_add_f32_dpp v44, v39, v44 quad_perm:[3,3,3,3] row_mask:0xf bank_mask:0xf
    s_waitcnt lgkmcnt(1)
    v_mfma_f32_16x16x32_bf16 v[16:19], v[24:27], v[56:59], v[16:19]
    ds_read_b128 v[56:59], v45 offset:3072
    v_cndmask_b32 v12, v12, v44, s[66:67]
    v_mfma_f32_16x16x32_bf16 v[40:43], v[32:35], a[28:31], v[40:43]
    v_mfma_f32_16x16x32_bf16 v[36:39], v[20:23], a[32:35], 0
    v_mfma_f32_16x16x32_bf16 v[36:39], v[24:27], a[36:39], v[36:39]
    s_waitcnt lgkmcnt(1)
    v_mfma_f32_16x16x32_bf16 v[16:19], v[28:31], v[60:63], v[16:19]
    ds_read_b128 v[60:63], v45 offset:4096
    s_nop 2
    v_mov_b32_dpp v44, v40 quad_perm:[0,0,0,0] row_mask:0xf bank_mask:0xf
    v_mfma_f32_16x16x32_bf16 v[36:39], v[28:31], a[40:43], v[36:39]
    v_add_f32_dpp v44, v41, v44 quad_perm:[1,1,1,1] row_mask:0xf bank_mask:0xf
    v_add_f32_dpp v44, v42, v44 quad_perm:[2,2,2,2] row_mask:0xf bank_mask:0xf
    v_mfma_f32_16x16x32_bf16 v[36:39], v[32:35], a[44:47], v[36:39]
    v_add_f32_dpp v44, v43, v44 quad_perm:[3,3,3,3] row_mask:0xf bank_mask:0xf
    v_cndmask_b32 v12, v12, v44, s[68:69]
    v_mfma_f32_16x16x32_bf16 v[40:43], v[20:23], a[48:51], 0
    s_waitcnt lgkmcnt(1)
    v_mfma_f32_16x16x32_bf16 v[16:19], v[32:35], v[56:59], v[16:19]
    ds_read_b128 v[56:59], v45 offset:5120
    v_mfma_f32_16x16x32_bf16 v[40:43], v[24:27], a[52:55], v[40:43]
    s_nop 0
    v_mov_b32_dpp v44, v36 quad_perm:[0,0,0,0] row_mask:0xf bank_mask:0xf
    v_add_f32_dpp v44, v37, v44 quad_perm:[1,1,1,1] row_mask:0xf bank_mask:0xf
    v_mfma_f32_16x16x32_bf16 v[40:43], v[28:31], a[56:59], v[40:43]
    v_add_f32_dpp v44, v38, v44 quad_perm:[2,2,2,2] row_mask:0xf bank_mask:0xf
    v_add_f32_dpp v44, v39, v44 quad_perm:[3,3,3,3] row_mask:0xf bank_mask:0xf
    v_mfma_f32_16x16x32_bf16 v[40:43], v[32:35], a[60:63], v[40:43]
    v_cndmask_b32 v13, v13, v44, s[62:63]
    v_mov_b32_dpp v44, v16 quad_perm:[0,0,0,0] row_mask:0xf bank_mask:0xf
    v_mfma_f32_16x16x32_bf16 v[36:39], v[20:23], a[64:67], 0
    v_add_f32_dpp v44, v17, v44 quad_perm:[1,1,1,1] row_mask:0xf bank_mask:0xf
    v_add_f32_dpp v44, v18, v44 quad_perm:[2,2,2,2] row_mask:0xf bank_mask:0xf
    v_add_f32_dpp v44, v19, v44 quad_perm:[3,3,3,3] row_mask:0xf bank_mask:0xf
    v_cndmask_b32 v12, v12, v44, s[62:63]
    s_waitcnt lgkmcnt(1)
    v_mfma_f32_16x16x32_bf16 v[16:19], v[20:23], v[60:63], 0
    ds_read_b128 v[60:63], v45 offset:6144
    v_mfma_f32_16x16x32_bf16 v[36:39], v[24:27], a[68:71], v[36:39]
    v_mov_b32_dpp v44, v40 quad_perm:[0,0,0,0] row_mask:0xf bank_mask:0xf
    v_add_f32_dpp v44, v41, v44 quad_perm:[1,1,1,1] row_mask:0xf bank_mask:0xf
    v_mfma_f32_16x16x32_bf16 v[36:39], v[28:31], a[72:75], v[36:39]
    v_add_f32_dpp v44, v42, v44 quad_perm:[2,2,2,2] row_mask:0xf bank_mask:0xf
    v_add_f32_dpp v44, v43, v44 quad_perm:[3,3,3,3] row_mask:0xf bank_mask:0xf
    v_mfma_f32_16x16x32_bf16 v[36:39], v[32:35], a[76:79], v[36:39]
    v_cndmask_b32 v13, v13, v44, s[64:65]
    s_waitcnt lgkmcnt(1)
    v_mfma_f32_16x16x32_bf16 v[16:19], v[24:27], v[56:59], v[16:19]
    ds_read_b128 v[56:59], v45 offset:7168
    v_mfma_f32_16x16x32_bf16 v[40:43], v[20:23], a[80:83], 0
    v_mfma_f32_16x16x32_bf16 v[40:43], v[24:27], a[84:87], v[40:43]
    s_nop 1
    v_mov_b32_dpp v44, v36 quad_perm:[0,0,0,0] row_mask:0xf bank_mask:0xf
    v_add_f32_dpp v44, v37, v44 quad_perm:[1,1,1,1] row_mask:0xf bank_mask:0xf
    v_mfma_f32_16x16x32_bf16 v[40:43], v[28:31], a[88:91], v[40:43]
    v_add_f32_dpp v44, v38, v44 quad_perm:[2,2,2,2] row_mask:0xf bank_mask:0xf
    v_add_f32_dpp v44, v39, v44 quad_perm:[3,3,3,3] row_mask:0xf bank_mask:0xf
    s_waitcnt lgkmcnt(1)
    v_mfma_f32_16x16x32_bf16 v[16:19], v[28:31], v[60:63], v[16:19]
    v_cndmask_b32 v13, v13, v44, s[66:67]
    v_mfma_f32_16x16x32_bf16 v[40:43], v[32:35], a[92:95], v[40:43]
    v_mfma_f32_16x16x32_bf16 v[36:39], v[20:23], a[96:99], 0
    v_mfma_f32_16x16x32_bf16 v[36:39], v[24:27], a[100:103], v[36:39]
    s_waitcnt lgkmcnt(0)
    v_mfma_f32_16x16x32_bf16 v[16:19], v[32:35], v[56:59], v[16:19]
    s_nop 3
    v_mov_b32_dpp v44, v40 quad_perm:[0,0,0,0] row_mask:0xf bank_mask:0xf
    v_mfma_f32_16x16x32_bf16 v[36:39], v[28:31], a[104:107], v[36:39]
    v_add_f32_dpp v44, v41, v44 quad_perm:[1,1,1,1] row_mask:0xf bank_mask:0xf
    v_add_f32_dpp v44, v42, v44 quad_perm:[2,2,2,2] row_mask:0xf bank_mask:0xf
    v_mfma_f32_16x16x32_bf16 v[36:39], v[32:35], a[108:111], v[36:39]
    v_add_f32_dpp v44, v43, v44 quad_perm:[3,3,3,3] row_mask:0xf bank_mask:0xf
    v_cndmask_b32 v13, v13, v44, s[68:69]
    v_mov_b32_dpp v44, v16 quad_perm:[0,0,0,0] row_mask:0xf bank_mask:0xf
    v_add_f32_dpp v44, v17, v44 quad_perm:[1,1,1,1] row_mask:0xf bank_mask:0xf
    v_add_f32_dpp v44, v18, v44 quad_perm:[2,2,2,2] row_mask:0xf bank_mask:0xf
    v_add_f32_dpp v44, v19, v44 quad_perm:[3,3,3,3] row_mask:0xf bank_mask:0xf
    v_cndmask_b32 v12, v12, v44, s[64:65]
    s_nop 0
    v_mov_b32_dpp v44, v36 quad_perm:[0,0,0,0] row_mask:0xf bank_mask:0xf
    v_add_f32_dpp v44, v37, v44 quad_perm:[1,1,1,1] row_mask:0xf bank_mask:0xf
    v_add_f32_dpp v44, v38, v44 quad_perm:[2,2,2,2] row_mask:0xf bank_mask:0xf
    v_add_f32_dpp v44, v39, v44 quad_perm:[3,3,3,3] row_mask:0xf bank_mask:0xf
    v_cndmask_b32 v14, v14, v44, s[62:63]
    v_max3_f32 v44, v12, v13, v14
    s_nop 1
    v_max_f32_dpp v44, v44, v44 quad_perm:[1,0,3,2] row_mask:0xf bank_mask:0xf
    s_nop 1
    v_max_f32_dpp v44, v44, v44 quad_perm:[2,3,0,1] row_mask:0xf bank_mask:0xf
    s_nop 1
    v_max_f32_dpp v44, v44, v44 row_half_mirror row_mask:0xf bank_mask:0xf
    s_nop 1
    v_max_f32_dpp v44, v44, v44 row_mirror row_mask:0xf bank_mask:0xf
    s_nop 1
    v_max_f32_dpp v44, v44, v44 row_bcast:15 row_mask:0xa bank_mask:0xf
    s_nop 1
    v_max_f32_dpp v44, v44, v44 row_bcast:31 row_mask:0xc bank_mask:0xf
    s_nop 0
    v_readlane_b32 s44, v44, 63
    s_nop 1
    v_mov_b32 v7, s44
    v_mul_f32 v7, s82, v7
    v_fma_f32 v12, v12, s82, -v7
    v_fma_f32 v13, v13, s82, -v7
    v_fma_f32 v14, v14, s82, -v7
    v_exp_f32 v12, v12
    v_exp_f32 v13, v13
    v_exp_f32 v14, v14
    v_add_f32 v15, v12, v13
    v_add_f32 v15, v15, v14
    v_cvt_pk_bf16_f32 v12, v12, v12
    v_cvt_pk_bf16_f32 v13, v13, v13
    v_cvt_pk_bf16_f32 v14, v14, v14
    s_nop 0
    s_setpc_b64 s[78:79]
S_vA:
    s_add_u32 s44, s37, 36864
    v_add_u32 v45, s44, v2
    ds_read_b128 v[56:59], v45 offset:0
    ds_read_b128 v[60:63], v45 offset:1024
    v_mov_b32_dpp v36, v12 row_half_mirror row_mask:0xf bank_mask:0xf
    v_mov_b32_dpp v37, v13 row_half_mirror row_mask:0xf bank_mask:0xf
    v_mov_b32_dpp v38, v14 row_half_mirror row_mask:0xf bank_mask:0xf
    v_and_b32_dpp v20, v12, v8 quad_perm:[2,2,2,2] row_mask:0xf bank_mask:0xf
    v_and_b32_dpp v21, v12, v9 quad_perm:[2,2,2,2] row_mask:0xf bank_mask:0xf
    v_and_b32_dpp v22, v36, v10 quad_perm:[1,1,1,1] row_mask:0xf bank_mask:0xf
    v_and_b32_dpp v23, v36, v11 quad_perm:[1,1,1,1] row_mask:0xf bank_mask:0xf
    v_and_b32_dpp v24, v36, v8 quad_perm:[1,1,1,1] row_mask:0xf bank_mask:0xf
    v_and_b32_dpp v25, v36, v9 quad_perm:[1,1,1,1] row_mask:0xf bank_mask:0xf
    v_and_b32_dpp v26, v12, v10 quad_perm:[2,2,2,2] row_mask:0xf bank_mask:0xf
    v_and_b32_dpp v27, v12, v11 quad_perm:[2,2,2,2] row_mask:0xf bank_mask:0xf
    v_and_b32_dpp v28, v12, v8 quad_perm:[0,0,0,0] row_mask:0xf bank_mask:0xf
    v_and_b32_dpp v29, v12, v9 quad_perm:[0,0,0,0] row_mask:0xf bank_mask:0xf
    v_and_b32_dpp v30, v36, v10 quad_perm:[3,3,3,3] row_mask:0xf bank_mask:0xf
    v_and_b32_dpp v31, v36, v11 quad_perm:[3,3,3,3] row_mask:0xf bank_mask:0xf
    v_mfma_f32_16x16x32_bf16 v[16:19], v[20:23], a[112:115], 0
    v_and_b32_dpp v32, v12, v8 quad_perm:[3,3,3,3] row_mask:0xf bank_mask:0xf
    v_and_b32_dpp v33, v12, v9 quad_perm:[3,3,3,3] row_mask:0xf bank_mask:0xf
    v_mfma_f32_16x16x32_bf16 v[40:43], v[20:23], a[116:119], 0
    v_and_b32_dpp v34, v36, v10 quad_perm:[0,0,0,0] row_mask:0xf bank_mask:0xf
    v_and_b32_dpp v35, v36, v11 quad_perm:[0,0,0,0] row_mask:0xf bank_mask:0xf
    s_waitcnt lgkmcnt(1)
    v_mfma_f32_16x16x32_bf16 v[16:19], v[28:31], v[56:59], v[16:19]
    ds_read_b128 v[56:59], v45 offset:2048
    v_mfma_f32_16x16x32_bf16 v[16:19], v[24:27], a[120:123], v[16:19]
    v_and_b32_dpp v20, v36, v8 quad_perm:[0,0,0,0] row_mask:0xf bank_mask:0xf
    v_and_b32_dpp v21, v36, v9 quad_perm:[0,0,0,0] row_mask:0xf bank_mask:0xf
    v_mfma_f32_16x16x32_bf16 v[40:43], v[24:27], a[124:127], v[40:43]
    v_and_b32_dpp v22, v12, v10 quad_perm:[3,3,3,3] row_mask:0xf bank_mask:0xf
    v_and_b32_dpp v23, v12, v11 quad_perm:[3,3,3,3] row_mask:0xf bank_mask:0xf
    s_waitcnt lgkmcnt(1)
    v_mfma_f32_16x16x32_bf16 v[40:43], v[28:31], v[60:63], v[40:43]
    ds_read_b128 v[60:63], v45 offset:3072
    v_add_f32_dpp v15, v15, v15 quad_perm:[1,0,3,2] row_mask:0xf bank_mask:0xf
    s_setpc_b64 s[78:79]
S_vA2:
    v_mfma_f32_16x16x32_bf16 v[16:19], v[32:35], a[128:131], v[16:19]
    v_and_b32_dpp v28, v36, v8 quad_perm:[3,3,3,3] row_mask:0xf bank_mask:0xf
    v_and_b32_dpp v29, v36, v9 quad_perm:[3,3,3,3] row_mask:0xf bank_mask:0xf
    v_and_b32_dpp v30, v12, v10 quad_perm:[0,0,0,0] row_mask:0xf bank_mask:0xf
    v_mfma_f32_16x16x32_bf16 v[40:43], v[32:35], a[132:135], v[40:43]
    v_and_b32_dpp v31, v12, v11 quad_perm:[0,0,0,0] row_mask:0xf bank_mask:0xf
    v_and_b32_dpp v24, v13, v8 quad_perm:[0,0,0,0] row_mask:0xf bank_mask:0xf
    v_and_b32_dpp v25, v13, v9 quad_perm:[0,0,0,0] row_mask:0xf bank_mask:0xf
    s_waitcnt lgkmcnt(1)
    v_mfma_f32_16x16x32_bf16 v[16:19], v[28:31], v[56:59], v[16:19]
    ds_read_b128 v[56:59], v45 offset:4096
    v_and_b32_dpp v26, v37, v10 quad_perm:[3,3,3,3] row_mask:0xf bank_mask:0xf
    v_and_b32_dpp v27, v37, v11 quad_perm:[3,3,3,3] row_mask:0xf bank_mask:0xf
    v_mfma_f32_16x16x32_bf16 v[16:19], v[20:23], a[136:139], v[16:19]
    v_and_b32_dpp v32, v37, v8 quad_perm:[3,3,3,3] row_mask:0xf bank_mask:0xf
    v_and_b32_dpp v33, v37, v9 quad_perm:[3,3,3,3] row_mask:0xf bank_mask:0xf
    v_mfma_f32_16x16x32_bf16 v[40:43], v[20:23], a[140:143], v[40:43]
    v_and_b32_dpp v34, v13, v10 quad_perm:[0,0,0,0] row_mask:0xf bank_mask:0xf
    v_and_b32_dpp v35, v13, v11 quad_perm:[0,0,0,0] row_mask:0xf bank_mask:0xf
    s_waitcnt lgkmcnt(1)
    v_mfma_f32_16x16x32_bf16 v[40:43], v[28:31], v[60:63], v[40:43]
    ds_read_b128 v[60:63], v45 offset:5120
    v_add_f32_dpp v15, v15, v15 quad_perm:[2,3,0,1] row_mask:0xf bank_mask:0xf
    v_mfma_f32_16x16x32_bf16 v[16:19], v[24:27], a[144:147], v[16:19]
    v_and_b32_dpp v28, v12, v8 quad_perm:[1,1,1,1] row_mask:0xf bank_mask:0xf
    v_and_b32_dpp v29, v12, v9 quad_perm:[1,1,1,1] row_mask:0xf bank_mask:0xf
    v_and_b32_dpp v30, v36, v10 quad_perm:[2,2,2,2] row_mask:0xf bank_mask:0xf
    v_mfma_f32_16x16x32_bf16 v[40:43], v[24:27], a[148:151], v[40:43]
    v_and_b32_dpp v31, v36, v11 quad_perm:[2,2,2,2] row_mask:0xf bank_mask:0xf
    v_and_b32_dpp v20, v13, v8 quad_perm:[1,1,1,1] row_mask:0xf bank_mask:0xf
    v_and_b32_dpp v21, v13, v9 quad_perm:[1,1,1,1] row_mask:0xf bank_mask:0xf
    s_waitcnt lgkmcnt(1)
    v_mfma_f32_16x16x32_bf16 v[16:19], v[28:31], v[56:59], v[16:19]
    ds_read_b128 v[56:59], v45 offset:6144
    v_and_b32_dpp v22, v37, v10 quad_perm:[2,2,2,2] row_mask:0xf bank_mask:0xf
    v_and_b32_dpp v23, v37, v11 quad_perm:[2,2,2,2] row_mask:0xf bank_mask:0xf
    v_mfma_f32_16x16x32_bf16 v[16:19], v[32:35], a[152:155], v[16:19]
    v_and_b32_dpp v24, v37, v8 quad_perm:[2,2,2,2] row_mask:0xf bank_mask:0xf
    v_and_b32_dpp v25, v37, v9 quad_perm:[2,2,2,2] row_mask:0xf bank_mask:0xf
    v_mfma_f32_16x16x32_bf16 v[40:43], v[32:35], a[156:159], v[40:43]
    v_and_b32_dpp v26, v13, v10 quad_perm:[1,1,1,1] row_mask:0xf bank_mask:0xf
    v_and_b32_dpp v27, v13, v11 quad_perm:[1,1,1,1] row_mask:0xf bank_mask:0xf
    s_waitcnt lgkmcnt(1)
    v_mfma_f32_16x16x32_bf16 v[40:43], v[28:31], v[60:63], v[40:43]
    ds_read_b128 v[60:63], v45 offset:7168
    v_add_f32_dpp v15, v15, v15 row_half_mirror row_mask:0xf bank_mask:0xf
    v_mfma_f32_16x16x32_bf16 v[16:19], v[20:23], a[160:163], v[16:19]
    v_and_b32_dpp v28, v36, v8 quad_perm:[2,2,2,2] row_mask:0xf bank_mask:0xf
    v_and_b32_dpp v29, v36, v9 quad_perm:[2,2,2,2] row_mask:0xf bank_mask:0xf
    v_and_b32_dpp v30, v12, v10 quad_perm:[1,1,1,1] row_mask:0xf bank_mask:0xf
    v_mfma_f32_16x16x32_bf16 v[40:43], v[20:23], a[164:167], v[40:43]
    v_and_b32_dpp v31, v12, v11 quad_perm:[1,1,1,1] row_mask:0xf bank_mask:0xf
    v_and_b32_dpp v32, v13, v8 quad_perm:[2,2,2,2] row_mask:0xf bank_mask:0xf
    v_and_b32_dpp v33, v13, v9 quad_perm:[2,2,2,2] row_mask:0xf bank_mask:0xf
    s_waitcnt lgkmcnt(1)
    v_mfma_f32_16x16x32_bf16 v[16:19], v[28:31], v[56:59], v[16:19]
    v_and_b32 v45, 0xffffff7f, v45
    ds_read_b128 v[56:59], v45 offset:8192
    v_and_b32_dpp v34, v37, v10 quad_perm:[1,1,1,1] row_mask:0xf bank_mask:0xf
    v_and_b32_dpp v35, v37, v11 quad_perm:[1,1,1,1] row_mask:0xf bank_mask:0xf
    v_mfma_f32_16x16x32_bf16 v[16:19], v[24:27], a[168:171], v[16:19]
    v_and_b32_dpp v20, v37, v8 quad_perm:[1,1,1,1] row_mask:0xf bank_mask:0xf
    v_and_b32_dpp v21, v37, v9 quad_perm:[1,1,1,1] row_mask:0xf bank_mask:0xf
    v_mfma_f32_16x16x32_bf16 v[40:43], v[24:27], a[172:175], v[40:43]
    v_and_b32_dpp v22, v13, v10 quad_perm:[2,2,2,2] row_mask:0xf bank_mask:0xf
    v_and_b32_dpp v23, v13, v11 quad_perm:[2,2,2,2] row_mask:0xf bank_mask:0xf
    s_waitcnt lgkmcnt(1)
    v_mfma_f32_16x16x32_bf16 v[40:43], v[28:31], v[60:63], v[40:43]
    ds_read_b128 v[60:63], v45 offset:8320
    v_add_f32_dpp v15, v15, v15 row_mirror row_mask:0xf bank_mask:0xf
    v_mfma_f32_16x16x32_bf16 v[16:19], v[32:35], a[176:179], v[16:19]
    v_and_b32_dpp v28, v14, v8 quad_perm:[1,1,1,1] row_mask:0xf bank_mask:0xf
    v_and_b32_dpp v29, v14, v9 quad_perm:[1,1,1,1] row_mask:0xf bank_mask:0xf
    v_and_b32_dpp v30, v38, v10 quad_perm:[2,2,2,2] row_mask:0xf bank_mask:0xf
    v_mfma_f32_16x16x32_bf16 v[40:43], v[32:35], a[180:183], v[40:43]
    v_and_b32_dpp v31, v38, v11 quad_perm:[2,2,2,2] row_mask:0xf bank_mask:0xf
    v_and_b32_dpp v24, v13, v8 quad_perm:[3,3,3,3] row_mask:0xf bank_mask:0xf
    v_and_b32_dpp v25, v13, v9 quad_perm:[3,3,3,3] row_mask:0xf bank_mask:0xf
    s_waitcnt lgkmcnt(1)
    v_mfma_f32_16x16x32_bf16 v[16:19], v[28:31], v[56:59], v[16:19]
    v_and_b32_dpp v26, v37, v10 quad_perm:[0,0,0,0] row_mask:0xf bank_mask:0xf
    v_and_b32_dpp v27, v37, v11 quad_perm:[0,0,0,0] row_mask:0xf bank_mask:0xf
    v_mfma_f32_16x16x32_bf16 v[16:19], v[20:23], a[184:187], v[16:19]
    v_and_b32_dpp v32, v37, v8 quad_perm:[0,0,0,0] row_mask:0xf bank_mask:0xf
    v_and_b32_dpp v33, v37, v9 quad_perm:[0,0,0,0] row_mask:0xf bank_mask:0xf
    v_mfma_f32_16x16x32_bf16 v[40:43], v[20:23], a[188:191], v[40:43]
    v_and_b32_dpp v34, v13, v10 quad_perm:[3,3,3,3] row_mask:0xf bank_mask:0xf
    v_and_b32_dpp v35, v13, v11 quad_perm:[3,3,3,3] row_mask:0xf bank_mask:0xf
    s_waitcnt lgkmcnt(0)
    v_mfma_f32_16x16x32_bf16 v[40:43], v[28:31], v[60:63], v[40:43]
    v_add_f32_dpp v15, v15, v15 row_bcast:15 row_mask:0xa bank_mask:0xf
    s_setpc_b64 s[78:79]
S_vA3:
    v_mfma_f32_16x16x32_bf16 v[16:19], v[24:27], a[192:195], v[16:19]
    v_and_b32_dpp v20, v14, v8 quad_perm:[0,0,0,0] row_mask:0xf bank_mask:0xf
    v_and_b32_dpp v21, v14, v9 quad_perm:[0,0,0,0] row_mask:0xf bank_mask:0xf
    v_mfma_f32_16x16x32_bf16 v[40:43], v[24:27], a[196:199], v[40:43]
    v_and_b32_dpp v22, v38, v10 quad_perm:[3,3,3,3] row_mask:0xf bank_mask:0xf
    v_and_b32_dpp v23, v38, v11 quad_perm:[3,3,3,3] row_mask:0xf bank_mask:0xf
    v_mfma_f32_16x16x32_bf16 v[16:19], v[32:35], a[200:203], v[16:19]
    v_and_b32_dpp v24, v38, v8 quad_perm:[3,3,3,3] row_mask:0xf bank_mask:0xf
    v_and_b32_dpp v25, v38, v9 quad_perm:[3,3,3,3] row_mask:0xf bank_mask:0xf
    v_mfma_f32_16x16x32_bf16 v[40:43], v[32:35], a[204:207], v[40:43]
    v_and_b32_dpp v26, v14, v10 quad_perm:[0,0,0,0] row_mask:0xf bank_mask:0xf
    v_and_b32_dpp v27, v14, v11 quad_perm:[0,0,0,0] row_mask:0xf bank_mask:0xf
    v_add_f32_dpp v15, v15, v15 row_bcast:31 row_mask:0xc bank_mask:0xf
    v_mfma_f32_16x16x32_bf16 v[16:19], v[20:23], a[208:211], v[16:19]
    v_mfma_f32_16x16x32_bf16 v[40:43], v[20:23], a[212:215], v[40:43]
    v_mfma_f32_16x16x32_bf16 v[16:19], v[24:27], a[216:219], v[16:19]
    v_mfma_f32_16x16x32_bf16 v[40:43], v[24:27], a[220:223], v[40:43]
    v_add_u32 v44, s48, v6
    s_lshl_b32 s44, s59, 2
    s_add_u32 s45, s44, s3
    s_lshl_b32 s45, s45, 3
    v_add_u32 v45, s45, v4
    v_mov_b32 v36, v7
    v_mov_b32 v37, v15
    v_mov_b32 v38, 1
    v_add_u32 v39, s44, v4
    s_mov_b32 exec_hi, 0xff00ff00
    s_mov_b32 exec_lo, 0x00ff00ff
    ds_write_b128 v44, v[16:19]
    ds_write_b128 v44, v[40:43] offset:256
    s_mov_b32 exec_hi, 0x80000000
    s_mov_b32 exec_lo, 0
    ds_write_b64 v45, v[36:37] offset:8192
    ds_add_rtn_u32 v38, v39, v38 offset:10368
    s_mov_b64 exec, -1
    s_branch S_A
S_kB:
    s_add_u32 s44, s37, 73728
    v_add_u32 v45, s44, v2
    ds_read_b128 v[56:59], v45 offset:8192
    ds_read_b128 v[60:63], v45 offset:0
    v_mov_b32 v14, 0xff800000
    s_waitcnt lgkmcnt(2)
    v_cndmask_b32 v20, 0, v40, s[70:71]
    v_cndmask_b32 v21, 0, v41, s[70:71]
    v_cndmask_b32 v22, 0, v42, s[70:71]
    v_cndmask_b32 v23, 0, v43, s[70:71]
    v_cndmask_b32 v24, 0, v40, s[72:73]
    v_cndmask_b32 v25, 0, v41, s[72:73]
    v_cndmask_b32 v26, 0, v42, s[72:73]
    v_cndmask_b32 v27, 0, v43, s[72:73]
    v_cndmask_b32 v28, 0, v40, s[74:75]
    v_cndmask_b32 v29, 0, v41, s[74:75]
    v_cndmask_b32 v30, 0, v42, s[74:75]
    v_cndmask_b32 v31, 0, v43, s[74:75]
    v_cndmask_b32 v32, 0, v40, s[76:77]
    v_cndmask_b32 v33, 0, v41, s[76:77]
    v_cndmask_b32 v34, 0, v42, s[76:77]
    v_cndmask_b32 v35, 0, v43, s[76:77]
    s_waitcnt lgkmcnt(1)
    v_mfma_f32_16x16x32_bf16 v[16:19], v[40:43], v[56:59], 0
    ds_read_b128 v[56:59], v45 offset:1024
    v_mfma_f32_16x16x32_bf16 v[36:39], v[20:23], a[224:227], 0
    v_mfma_f32_16x16x32_bf16 v[36:39], v[24:27], a[228:231], v[36:39]
    v_mfma_f32_16x16x32_bf16 v[36:39], v[28:31], a[232:235], v[36:39]
    s_nop 3
    v_mov_b32_dpp v44, v16 quad_perm:[0,0,0,0] row_mask:0xf bank_mask:0xf
    v_add_f32_dpp v44, v17, v44 quad_perm:[1,1,1,1] row_mask:0xf bank_mask:0xf
    v_mfma_f32_16x16x32_bf16 v[36:39], v[32:35], a[236:239], v[36:39]
    v_add_f32_dpp v44, v18, v44 quad_perm:[2,2,2,2] row_mask:0xf bank_mask:0xf
    v_add_f32_dpp v44, v19, v44 quad_perm:[3,3,3,3] row_mask:0xf bank_mask:0xf
    s_nop 1
    v_mov_b32_dpp v44, v44 row_shl:4 row_mask:0x2 bank_mask:0xf
    s_nop 1
    v_mov_b32_dpp v44, v44 row_shl:8 row_mask:0x4 bank_mask:0xf
    s_nop 1
    v_mov_b32_dpp v44, v44 row_shl:12 row_mask:0x8 bank_mask:0xf
    v_cndmask_b32 v14, v14, v44, s[80:81]
    s_waitcnt lgkmcnt(1)
    v_mfma_f32_16x16x32_bf16 v[16:19], v[20:23], v[60:63], 0
    ds_read_b128 v[60:63], v45 offset:2048
    v_mfma_f32_16x16x32_bf16 v[40:43], v[20:23], a[240:243], 0
    v_mfma_f32_16x16x32_bf16 v[40:43], v[24:27], a[244:247], v[40:43]
    v_mov_b32_dpp v44, v36 quad_perm:[0,0,0,0] row_mask:0xf bank_mask:0xf
    v_add_f32_dpp v44, v37, v44 quad_perm:[1,1,1,1] row_mask:0xf bank_mask:0xf
    v_mfma_f32_16x16x32_bf16 v[40:43], v[28:31], a[248:251], v[40:43]
    v_add_f32_dpp v44, v38, v44 quad_perm:[2,2,2,2] row_mask:0xf bank_mask:0xf
    v_add_f32_dpp v44, v39, v44 quad_perm:[3,3,3,3] row_mask:0xf bank_mask:0xf
    s_waitcnt lgkmcnt(1)
    v_mfma_f32_16x16x32_bf16 v[16:19], v[24:27], v[56:59], v[16:19]
    ds_read_b128 v[56:59], v45 offset:3072
    v_cndmask_b32 v12, v12, v44, s[66:67]
    v_mfma_f32_16x16x32_bf16 v[40:43], v[32:35], a[252:255], v[40:43]
    v_mfma_f32_16x16x32_bf16 v[36:39], v[20:23], v[64:67], 0
    v_mfma_f32_16x16x32_bf16 v[36:39], v[24:27], v[68:71], v[36:39]
    s_waitcnt lgkmcnt(1)
    v_mfma_f32_16x16x32_bf16 v[16:19], v[28:31], v[60:63], v[16:19]
    ds_read_b128 v[60:63], v45 offset:4096
    s_nop 2
    v_mov_b32_dpp v44, v40 quad_perm:[0,0,0,0] row_mask:0xf bank_mask:0xf
    v_mfma_f32_16x16x32_bf16 v[36:39], v[28:31], v[72:75], v[36:39]
    v_add_f32_dpp v44, v41, v44 quad_perm:[1,1,1,1] row_mask:0xf bank_mask:0xf
    v_add_f32_dpp v44, v42, v44 quad_perm:[2,2,2,2] row_mask:0xf bank_mask:0xf
    v_mfma_f32_16x16x32_bf16 v[36:39], v[32:35], v[76:79], v[36:39]
    v_add_f32_dpp v44, v43, v44 quad_perm:[3,3,3,3] row_mask:0xf bank_mask:0xf
    v_cndmask_b32 v12, v12, v44, s[68:69]
    v_mfma_f32_16x16x32_bf16 v[40:43], v[20:23], v[80:83], 0
    s_waitcnt lgkmcnt(1)
    v_mfma_f32_16x16x32_bf16 v[16:19], v[32:35], v[56:59], v[16:19]
    ds_read_b128 v[56:59], v45 offset:5120
    v_mfma_f32_16x16x32_bf16 v[40:43], v[24:27], v[84:87], v[40:43]
    s_nop 0
    v_mov_b32_dpp v44, v36 quad_perm:[0,0,0,0] row_mask:0xf bank_mask:0xf
    v_add_f32_dpp v44, v37, v44 quad_perm:[1,1,1,1] row_mask:0xf bank_mask:0xf
    v_mfma_f32_16x16x32_bf16 v[40:43], v[28:31], v[88:91], v[40:43]
    v_add_f32_dpp v44, v38, v44 quad_perm:[2,2,2,2] row_mask:0xf bank_mask:0xf
    v_add_f32_dpp v44, v39, v44 quad_perm:[3,3,3,3] row_mask:0xf bank_mask:0xf
    v_mfma_f32_16x16x32_bf16 v[40:43], v[32:35], v[92:95], v[40:43]
    v_cndmask_b32 v13, v13, v44, s[62:63]
    v_mov_b32_dpp v44, v16 quad_perm:[0,0,0,0] row_mask:0xf bank_mask:0xf
    v_mfma_f32_16x16x32_bf16 v[36:39], v[20:23], v[96:99], 0
    v_add_f32_dpp v44, v17, v44 quad_perm:[1,1,1,1] row_mask:0xf bank_mask:0xf
    v_add_f32_dpp v44, v18, v44 quad_perm:[2,2,2,2] row_mask:0xf bank_mask:0xf
    v_add_f32_dpp v44, v19, v44 quad_perm:[3,3,3,3] row_mask:0xf bank_mask:0xf
    v_cndmask_b32 v12, v12, v44, s[62:63]
    s_waitcnt lgkmcnt(1)
    v_mfma_f32_16x16x32_bf16 v[16:19], v[20:23], v[60:63], 0
    ds_read_b128 v[60:63], v45 offset:6144
    v_mfma_f32_16x16x32_bf16 v[36:39], v[24:27], v[100:103], v[36:39]
    v_mov_b32_dpp v44, v40 quad_perm:[0,0,0,0] row_mask:0xf bank_mask:0xf
    v_add_f32_dpp v44, v41, v44 quad_perm:[1,1,1,1] row_mask:0xf bank_mask:0xf
    v_mfma_f32_16x16x32_bf16 v[36:39], v[28:31], v[104:107], v[36:39]
    v_add_f32_dpp v44, v42, v44 quad_perm:[2,2,2,2] row_mask:0xf bank_mask:0xf
    v_add_f32_dpp v44, v43, v44 quad_perm:[3,3,3,3] row_mask:0xf bank_mask:0xf
    v_mfma_f32_16x16x32_bf16 v[36:39], v[32:35], v[108:111], v[36:39]
    v_cndmask_b32 v13, v13, v44, s[64:65]
    s_waitcnt lgkmcnt(1)
    v_mfma_f32_16x16x32_bf16 v[16:19], v[24:27], v[56:59], v[16:19]
    ds_read_b128 v[56:59], v45 offset:7168
    v_mfma_f32_16x16x32_bf16 v[40:43], v[20:23], v[112:115], 0
    v_mfma_f32_16x16x32_bf16 v[40:43], v[24:27], v[116:119], v[40:43]
    s_nop 1
    v_mov_b32_dpp v44, v36 quad_perm:[0,0,0,0] row_mask:0xf bank_mask:0xf
    v_add_f32_dpp v44, v37, v44 quad_perm:[1,1,1,1] row_mask:0xf bank_mask:0xf
    v_mfma_f32_16x16x32_bf16 v[40:43], v[28:31], v[120:123], v[40:43]
    v_add_f32_dpp v44, v38, v44 quad_perm:[2,2,2,2] row_mask:0xf bank_mask:0xf
    v_add_f32_dpp v44, v39, v44 quad_perm:[3,3,3,3] row_mask:0xf bank_mask:0xf
    s_waitcnt lgkmcnt(1)
    v_mfma_f32_16x16x32_bf16 v[16:19], v[28:31], v[60:63], v[16:19]
    v_cndmask_b32 v13, v13, v44, s[66:67]
    v_mfma_f32_16x16x32_bf16 v[40:43], v[32:35], v[124:127], v[40:43]
    v_mfma_f32_16x16x32_bf16 v[36:39], v[20:23], v[128:131], 0
    v_mfma_f32_16x16x32_bf16 v[36:39], v[24:27], v[132:135], v[36:39]
    s_waitcnt lgkmcnt(0)
    v_mfma_f32_16x16x32_bf16 v[16:19], v[32:35], v[56:59], v[16:19]
    s_nop 3
    v_mov_b32_dpp v44, v40 quad_perm:[0,0,0,0] row_mask:0xf bank_mask:0xf
    v_mfma_f32_16x16x32_bf16 v[36:39], v[28:31], v[136:139], v[36:39]
    v_add_f32_dpp v44, v41, v44 quad_perm:[1,1,1,1] row_mask:0xf bank_mask:0xf
    v_add_f32_dpp v44, v42, v44 quad_perm:[2,2,2,2] row_mask:0xf bank_mask:0xf
    v_mfma_f32_16x16x32_bf16 v[36:39], v[32:35], v[140:143], v[36:39]
    v_add_f32_dpp v44, v43, v44 quad_perm:[3,3,3,3] row_mask:0xf bank_mask:0xf
    v_cndmask_b32 v13, v13, v44, s[68:69]
    v_mov_b32_dpp v44, v16 quad_perm:[0,0,0,0] row_mask:0xf bank_mask:0xf
    v_add_f32_dpp v44, v17, v44 quad_perm:[1,1,1,1] row_mask:0xf bank_mask:0xf
    v_add_f32_dpp v44, v18, v44 quad_perm:[2,2,2,2] row_mask:0xf bank_mask:0xf
    v_add_f32_dpp v44, v19, v44 quad_perm:[3,3,3,3] row_mask:0xf bank_mask:0xf
    v_cndmask_b32 v12, v12, v44, s[64:65]
    s_nop 0
    v_mov_b32_dpp v44, v36 quad_perm:[0,0,0,0] row_mask:0xf bank_mask:0xf
    v_add_f32_dpp v44, v37, v44 quad_perm:[1,1,1,1] row_mask:0xf bank_mask:0xf
    v_add_f32_dpp v44, v38, v44 quad_perm:[2,2,2,2] row_mask:0xf bank_mask:0xf
    v_add_f32_dpp v44, v39, v44 quad_perm:[3,3,3,3] row_mask:0xf bank_mask:0xf
    v_cndmask_b32 v14, v14, v44, s[62:63]
    v_max3_f32 v44, v12, v13, v14
    s_nop 1
    v_max_f32_dpp v44, v44, v44 quad_perm:[1,0,3,2] row_mask:0xf bank_mask:0xf
    s_nop 1
    v_max_f32_dpp v44, v44, v44 quad_perm:[2,3,0,1] row_mask:0xf bank_mask:0xf
    s_nop 1
    v_max_f32_dpp v44, v44, v44 row_half_mirror row_mask:0xf bank_mask:0xf
    s_nop 1
    v_max_f32_dpp v44, v44, v44 row_mirror row_mask:0xf bank_mask:0xf
    s_nop 1
    v_max_f32_dpp v44, v44, v44 row_bcast:15 row_mask:0xa bank_mask:0xf
    s_nop 1
    v_max_f32_dpp v44, v44, v44 row_bcast:31 row_mask:0xc bank_mask:0xf
    s_nop 0
    v_readlane_b32 s44, v44, 63
    s_nop 1
    v_mov_b32 v7, s44
    v_mul_f32 v7, s82, v7
    v_fma_f32 v12, v12, s82, -v7
    v_fma_f32 v13, v13, s82, -v7
    v_fma_f32 v14, v14, s82, -v7
    v_exp_f32 v12, v12
    v_exp_f32 v13, v13
    v_exp_f32 v14, v14
    v_add_f32 v15, v12, v13
    v_add_f32 v15, v15, v14
    v_cvt_pk_bf16_f32 v12, v12, v12
    v_cvt_pk_bf16_f32 v13, v13, v13
    v_cvt_pk_bf16_f32 v14, v14, v14
    s_nop 0
    s_setpc_b64 s[78:79]
S_vB:
    s_add_u32 s44, s37, 110592
    v_add_u32 v45, s44, v2
    ds_read_b128 v[56:59], v45 offset:0
    ds_read_b128 v[60:63], v45 offset:1024
    v_mov_b32_dpp v36, v12 row_half_mirror row_mask:0xf bank_mask:0xf
    v_mov_b32_dpp v37, v13 row_half_mirror row_mask:0xf bank_mask:0xf
    v_mov_b32_dpp v38, v14 row_half_mirror row_mask:0xf bank_mask:0xf
    v_and_b32_dpp v20, v12, v8 quad_perm:[2,2,2,2] row_mask:0xf bank_mask:0xf
    v_and_b32_dpp v21, v12, v9 quad_perm:[2,2,2,2] row_mask:0xf bank_mask:0xf
    v_and_b32_dpp v22, v36, v10 quad_perm:[1,1,1,1] row_mask:0xf bank_mask:0xf
    v_and_b32_dpp v23, v36, v11 quad_perm:[1,1,1,1] row_mask:0xf bank_mask:0xf
    v_and_b32_dpp v24, v36, v8 quad_perm:[1,1,1,1] row_mask:0xf bank_mask:0xf
    v_and_b32_dpp v25, v36, v9 quad_perm:[1,1,1,1] row_mask:0xf bank_mask:0xf
    v_and_b32_dpp v26, v12, v10 quad_perm:[2,2,2,2] row_mask:0xf bank_mask:0xf
    v_and_b32_dpp v27, v12, v11 quad_perm:[2,2,2,2] row_mask:0xf bank_mask:0xf
    v_and_b32_dpp v28, v12, v8 quad_perm:[0,0,0,0] row_mask:0xf bank_mask:0xf
    v_and_b32_dpp v29, v12, v9 quad_perm:[0,0,0,0] row_mask:0xf bank_mask:0xf
    v_and_b32_dpp v30, v36, v10 quad_perm:[3,3,3,3] row_mask:0xf bank_mask:0xf
    v_and_b32_dpp v31, v36, v11 quad_perm:[3,3,3,3] row_mask:0xf bank_mask:0xf
    v_mfma_f32_16x16x32_bf16 v[16:19], v[20:23], v[144:147], 0
    v_and_b32_dpp v32, v12, v8 quad_perm:[3,3,3,3] row_mask:0xf bank_mask:0xf
    v_and_b32_dpp v33, v12, v9 quad_perm:[3,3,3,3] row_mask:0xf bank_mask:0xf
    v_mfma_f32_16x16x32_bf16 v[40:43], v[20:23], v[148:151], 0
    v_and_b32_dpp v34, v36, v10 quad_perm:[0,0,0,0] row_mask:0xf bank_mask:0xf
    v_and_b32_dpp v35, v36, v11 quad_perm:[0,0,0,0] row_mask:0xf bank_mask:0xf
    s_waitcnt lgkmcnt(1)
    v_mfma_f32_16x16x32_bf16 v[16:19], v[28:31], v[56:59], v[16:19]
    ds_read_b128 v[56:59], v45 offset:2048
    v_mfma_f32_16x16x32_bf16 v[16:19], v[24:27], v[152:155], v[16:19]
    v_and_b32_dpp v20, v36, v8 quad_perm:[0,0,0,0] row_mask:0xf bank_mask:0xf
    v_and_b32_dpp v21, v36, v9 quad_perm:[0,0,0,0] row_mask:0xf bank_mask:0xf
    v_mfma_f32_16x16x32_bf16 v[40:43], v[24:27], v[156:159], v[40:43]
    v_and_b32_dpp v22, v12, v10 quad_perm:[3,3,3,3] row_mask:0xf bank_mask:0xf
    v_and_b32_dpp v23, v12, v11 quad_perm:[3,3,3,3] row_mask:0xf bank_mask:0xf
    s_waitcnt lgkmcnt(1)
    v_mfma_f32_16x16x32_bf16 v[40:43], v[28:31], v[60:63], v[40:43]
    ds_read_b128 v[60:63], v45 offset:3072
    v_add_f32_dpp v15, v15, v15 quad_perm:[1,0,3,2] row_mask:0xf bank_mask:0xf
    v_mfma_f32_16x16x32_bf16 v[16:19], v[32:35], v[160:163], v[16:19]
    v_and_b32_dpp v28, v36, v8 quad_perm:[3,3,3,3] row_mask:0xf bank_mask:0xf
    v_and_b32_dpp v29, v36, v9 quad_perm:[3,3,3,3] row_mask:0xf bank_mask:0xf
    v_and_b32_dpp v30, v12, v10 quad_perm:[0,0,0,0] row_mask:0xf bank_mask:0xf
    v_mfma_f32_16x16x32_bf16 v[40:43], v[32:35], v[164:167], v[40:43]
    v_and_b32_dpp v31, v12, v11 quad_perm:[0,0,0,0] row_mask:0xf bank_mask:0xf
    v_and_b32_dpp v24, v13, v8 quad_perm:[0,0,0,0] row_mask:0xf bank_mask:0xf
    v_and_b32_dpp v25, v13, v9 quad_perm:[0,0,0,0] row_mask:0xf bank_mask:0xf
    s_waitcnt lgkmcnt(1)
    v_mfma_f32_16x16x32_bf16 v[16:19], v[28:31], v[56:59], v[16:19]
    ds_read_b128 v[56:59], v45 offset:4096
    v_and_b32_dpp v26, v37, v10 quad_perm:[3,3,3,3] row_mask:0xf bank_mask:0xf
    v_and_b32_dpp v27, v37, v11 quad_perm:[3,3,3,3] row_mask:0xf bank_mask:0xf
    v_mfma_f32_16x16x32_bf16 v[16:19], v[20:23], v[168:171], v[16:19]
    v_and_b32_dpp v32, v37, v8 quad_perm:[3,3,3,3] row_mask:0xf bank_mask:0xf
    v_and_b32_dpp v33, v37, v9 quad_perm:[3,3,3,3] row_mask:0xf bank_mask:0xf
    v_mfma_f32_16x16x32_bf16 v[40:43], v[20:23], v[172:175], v[40:43]
    v_and_b32_dpp v34, v13, v10 quad_perm:[0,0,0,0] row_mask:0xf bank_mask:0xf
    v_and_b32_dpp v35, v13, v11 quad_perm:[0,0,0,0] row_mask:0xf bank_mask:0xf
    s_waitcnt lgkmcnt(1)
    v_mfma_f32_16x16x32_bf16 v[40:43], v[28:31], v[60:63], v[40:43]
    ds_read_b128 v[60:63], v45 offset:5120
    v_add_f32_dpp v15, v15, v15 quad_perm:[2,3,0,1] row_mask:0xf bank_mask:0xf
    v_mfma_f32_16x16x32_bf16 v[16:19], v[24:27], v[176:179], v[16:19]
    v_and_b32_dpp v28, v12, v8 quad_perm:[1,1,1,1] row_mask:0xf bank_mask:0xf
    v_and_b32_dpp v29, v12, v9 quad_perm:[1,1,1,1] row_mask:0xf bank_mask:0xf
    v_and_b32_dpp v30, v36, v10 quad_perm:[2,2,2,2] row_mask:0xf bank_mask:0xf
    v_mfma_f32_16x16x32_bf16 v[40:43], v[24:27], v[180:183], v[40:43]
    v_and_b32_dpp v31, v36, v11 quad_perm:[2,2,2,2] row_mask:0xf bank_mask:0xf
    v_and_b32_dpp v20, v13, v8 quad_perm:[1,1,1,1] row_mask:0xf bank_mask:0xf
    v_and_b32_dpp v21, v13, v9 quad_perm:[1,1,1,1] row_mask:0xf bank_mask:0xf
    s_waitcnt lgkmcnt(1)
    v_mfma_f32_16x16x32_bf16 v[16:19], v[28:31], v[56:59], v[16:19]
    ds_read_b128 v[56:59], v45 offset:6144
    v_and_b32_dpp v22, v37, v10 quad_perm:[2,2,2,2] row_mask:0xf bank_mask:0xf
    v_and_b32_dpp v23, v37, v11 quad_perm:[2,2,2,2] row_mask:0xf bank_mask:0xf
    v_mfma_f32_16x16x32_bf16 v[16:19], v[32:35], v[184:187], v[16:19]
    v_and_b32_dpp v24, v37, v8 quad_perm:[2,2,2,2] row_mask:0xf bank_mask:0xf
    v_and_b32_dpp v25, v37, v9 quad_perm:[2,2,2,2] row_mask:0xf bank_mask:0xf
    v_mfma_f32_16x16x32_bf16 v[40:43], v[32:35], v[188:191], v[40:43]
    v_and_b32_dpp v26, v13, v10 quad_perm:[1,1,1,1] row_mask:0xf bank_mask:0xf
    v_and_b32_dpp v27, v13, v11 quad_perm:[1,1,1,1] row_mask:0xf bank_mask:0xf
    s_waitcnt lgkmcnt(1)
    v_mfma_f32_16x16x32_bf16 v[40:43], v[28:31], v[60:63], v[40:43]
    ds_read_b128 v[60:63], v45 offset:7168
    v_add_f32_dpp v15, v15, v15 row_half_mirror row_mask:0xf bank_mask:0xf
    v_mfma_f32_16x16x32_bf16 v[16:19], v[20:23], v[192:195], v[16:19]
    v_and_b32_dpp v28, v36, v8 quad_perm:[2,2,2,2] row_mask:0xf bank_mask:0xf
    v_and_b32_dpp v29, v36, v9 quad_perm:[2,2,2,2] row_mask:0xf bank_mask:0xf
    v_and_b32_dpp v30, v12, v10 quad_perm:[1,1,1,1] row_mask:0xf bank_mask:0xf
    v_mfma_f32_16x16x32_bf16 v[40:43], v[20:23], v[196:199], v[40:43]
    v_and_b32_dpp v31, v12, v11 quad_perm:[1,1,1,1] row_mask:0xf bank_mask:0xf
    v_and_b32_dpp v32, v13, v8 quad_perm:[2,2,2,2] row_mask:0xf bank_mask:0xf
    v_and_b32_dpp v33, v13, v9 quad_perm:[2,2,2,2] row_mask:0xf bank_mask:0xf
    s_waitcnt lgkmcnt(1)
    v_mfma_f32_16x16x32_bf16 v[16:19], v[28:31], v[56:59], v[16:19]
    v_and_b32 v45, 0xffffff7f, v45
    ds_read_b128 v[56:59], v45 offset:8192
    v_and_b32_dpp v34, v37, v10 quad_perm:[1,1,1,1] row_mask:0xf bank_mask:0xf
    v_and_b32_dpp v35, v37, v11 quad_perm:[1,1,1,1] row_mask:0xf bank_mask:0xf
    v_mfma_f32_16x16x32_bf16 v[16:19], v[24:27], v[200:203], v[16:19]
    v_and_b32_dpp v20, v37, v8 quad_perm:[1,1,1,1] row_mask:0xf bank_mask:0xf
    v_and_b32_dpp v21, v37, v9 quad_perm:[1,1,1,1] row_mask:0xf bank_mask:0xf
    v_mfma_f32_16x16x32_bf16 v[40:43], v[24:27], v[204:207], v[40:43]
    v_and_b32_dpp v22, v13, v10 quad_perm:[2,2,2,2] row_mask:0xf bank_mask:0xf
    v_and_b32_dpp v23, v13, v11 quad_perm:[2,2,2,2] row_mask:0xf bank_mask:0xf
    s_waitcnt lgkmcnt(1)
    v_mfma_f32_16x16x32_bf16 v[40:43], v[28:31], v[60:63], v[40:43]
    ds_read_b128 v[60:63], v45 offset:8320
    v_add_f32_dpp v15, v15, v15 row_mirror row_mask:0xf bank_mask:0xf
    v_mfma_f32_16x16x32_bf16 v[16:19], v[32:35], v[208:211], v[16:19]
    v_and_b32_dpp v28, v14, v8 quad_perm:[1,1,1,1] row_mask:0xf bank_mask:0xf
    v_and_b32_dpp v29, v14, v9 quad_perm:[1,1,1,1] row_mask:0xf bank_mask:0xf
    v_and_b32_dpp v30, v38, v10 quad_perm:[2,2,2,2] row_mask:0xf bank_mask:0xf
    v_mfma_f32_16x16x32_bf16 v[40:43], v[32:35], v[212:215], v[40:43]
    v_and_b32_dpp v31, v38, v11 quad_perm:[2,2,2,2] row_mask:0xf bank_mask:0xf
    v_and_b32_dpp v24, v13, v8 quad_perm:[3,3,3,3] row_mask:0xf bank_mask:0xf
    v_and_b32_dpp v25, v13, v9 quad_perm:[3,3,3,3] row_mask:0xf bank_mask:0xf
    s_waitcnt lgkmcnt(1)
    v_mfma_f32_16x16x32_bf16 v[16:19], v[28:31], v[56:59], v[16:19]
    v_and_b32_dpp v26, v37, v10 quad_perm:[0,0,0,0] row_mask:0xf bank_mask:0xf
    v_and_b32_dpp v27, v37, v11 quad_perm:[0,0,0,0] row_mask:0xf bank_mask:0xf
    v_mfma_f32_16x16x32_bf16 v[16:19], v[20:23], v[216:219], v[16:19]
    v_and_b32_dpp v32, v37, v8 quad_perm:[0,0,0,0] row_mask:0xf bank_mask:0xf
    v_and_b32_dpp v33, v37, v9 quad_perm:[0,0,0,0] row_mask:0xf bank_mask:0xf
    v_mfma_f32_16x16x32_bf16 v[40:43], v[20:23], v[220:223], v[40:43]
    v_and_b32_dpp v34, v13, v10 quad_perm:[3,3,3,3] row_mask:0xf bank_mask:0xf
    v_and_b32_dpp v35, v13, v11 quad_perm:[3,3,3,3] row_mask:0xf bank_mask:0xf
    s_waitcnt lgkmcnt(0)
    v_mfma_f32_16x16x32_bf16 v[40:43], v[28:31], v[60:63], v[40:43]
    v_add_f32_dpp v15, v15, v15 row_bcast:15 row_mask:0xa bank_mask:0xf
    s_setpc_b64 s[78:79]
S_vB3:
    v_mfma_f32_16x16x32_bf16 v[16:19], v[24:27], v[224:227], v[16:19]
    v_and_b32_dpp v20, v14, v8 quad_perm:[0,0,0,0] row_mask:0xf bank_mask:0xf
    v_and_b32_dpp v21, v14, v9 quad_perm:[0,0,0,0] row_mask:0xf bank_mask:0xf
    v_mfma_f32_16x16x32_bf16 v[40:43], v[24:27], v[228:231], v[40:43]
    v_and_b32_dpp v22, v38, v10 quad_perm:[3,3,3,3] row_mask:0xf bank_mask:0xf
    v_and_b32_dpp v23, v38, v11 quad_perm:[3,3,3,3] row_mask:0xf bank_mask:0xf
    v_mfma_f32_16x16x32_bf16 v[16:19], v[32:35], v[232:235], v[16:19]
    v_and_b32_dpp v24, v38, v8 quad_perm:[3,3,3,3] row_mask:0xf bank_mask:0xf
    v_and_b32_dpp v25, v38, v9 quad_perm:[3,3,3,3] row_mask:0xf bank_mask:0xf
    v_mfma_f32_16x16x32_bf16 v[40:43], v[32:35], v[236:239], v[40:43]
    v_and_b32_dpp v26, v14, v10 quad_perm:[0,0,0,0] row_mask:0xf bank_mask:0xf
    v_and_b32_dpp v27, v14, v11 quad_perm:[0,0,0,0] row_mask:0xf bank_mask:0xf
    v_add_f32_dpp v15, v15, v15 row_bcast:31 row_mask:0xc bank_mask:0xf
    v_mfma_f32_16x16x32_bf16 v[16:19], v[20:23], v[240:243], v[16:19]
    v_mfma_f32_16x16x32_bf16 v[40:43], v[20:23], v[244:247], v[40:43]
    v_mfma_f32_16x16x32_bf16 v[16:19], v[24:27], v[248:251], v[16:19]
    v_mfma_f32_16x16x32_bf16 v[40:43], v[24:27], v[252:255], v[40:43]
    v_add_u32 v44, s48, v6
    s_lshl_b32 s44, s59, 2
    s_add_u32 s45, s44, s3
    s_lshl_b32 s45, s45, 3
    v_add_u32 v45, s45, v4
    v_mov_b32 v36, v7
    v_mov_b32 v37, v15
    v_mov_b32 v38, 1
    v_add_u32 v39, s44, v4
    s_mov_b32 exec_hi, 0xff00ff00
    s_mov_b32 exec_lo, 0x00ff00ff
    ds_write_b128 v44, v[16:19]
    ds_write_b128 v44, v[40:43] offset:256
    s_mov_b32 exec_hi, 0x80000000
    s_mov_b32 exec_lo, 0
    ds_write_b64 v45, v[36:37] offset:8192
    ds_add_rtn_u32 v38, v39, v38 offset:10368
    s_mov_b64 exec, -1
    s_branch S_A
S_A:
    s_and_b32 s45, s48, 0x1000
    s_add_u32 s45, s45, 147456
    v_lshrrev_b32 v39, 1, v2
    v_add_u32 v44, s45, v39
    s_lshl_b32 s44, s59, 5
    v_add_u32 v45, s44, v4
    ds_read_b128 v[56:59], v45 offset:8192
    ds_read_b128 v[60:63], v45 offset:8208
    ds_read_b64 v[20:21], v44 offset:0
    ds_read_b64 v[22:23], v44 offset:512
    ds_read_b64 v[24:25], v44 offset:1024
    ds_read_b64 v[26:27], v44 offset:1536
    ds_read_b64 v[28:29], v44 offset:2048
    ds_read_b64 v[30:31], v44 offset:2560
    ds_read_b64 v[32:33], v44 offset:3072
    ds_read_b64 v[34:35], v44 offset:3584
    s_lshl_b32 s45, s49, 17
    s_lshl_b32 s46, s4, 9
    s_add_u32 s45, s45, s46
    s_lshr_b32 s46, s45, 6
    s_add_u32 s46, s46, 2097152
    s_waitcnt lgkmcnt(10)
    v_readlane_b32 s44, v38, 63
    s_nop 0
    s_and_b32 s44, s44, 3
    s_cmp_eq_u32 s44, 3
    s_cbranch_scc1 S_A_ok
    s_waitcnt lgkmcnt(0)
    s_setpc_b64 s[78:79]
S_A_ok:
    s_waitcnt lgkmcnt(8)
    v_max3_f32 v36, v56, v58, v60
    v_max_f32 v36, v36, v62
    v_sub_f32 v56, v56, v36
    v_sub_f32 v58, v58, v36
    v_sub_f32 v60, v60, v36
    v_sub_f32 v62, v62, v36
    v_exp_f32 v56, v56
    v_exp_f32 v58, v58
    v_exp_f32 v60, v60
    v_exp_f32 v62, v62
    v_mul_f32 v37, v56, v57
    v_fmac_f32 v37, v58, v59
    v_fmac_f32 v37, v60, v61
    v_fmac_f32 v37, v62, v63
    s_waitcnt lgkmcnt(0)
    v_pk_add_f32 v[20:21], v[20:21], v[22:23]
    v_pk_add_f32 v[24:25], v[24:25], v[26:27]
    v_pk_add_f32 v[28:29], v[28:29], v[30:31]
    v_pk_add_f32 v[32:33], v[32:33], v[34:35]
    v_mul_f32 v20, v56, v20
    v_mul_f32 v21, v56, v21
    v_fmac_f32 v20, v58, v24
    v_fmac_f32 v21, v58, v25
    v_fmac_f32 v20, v60, v28
    v_fmac_f32 v21, v60, v29
    v_fmac_f32 v20, v62, v32
    v_fmac_f32 v21, v62, v33
    s_cmp_eq_u32 s51, 0
    s_cbranch_scc1 Lrs_132
    buffer_store_dwordx2 v[20:21], v39, s[24:27], s45 offen
    s_mov_b64 exec, 1
    buffer_store_dwordx2 v[36:37], v39, s[24:27], s46 offen
    s_mov_b64 exec, -1
    s_branch Lrs_133
Lrs_132:
    buffer_store_dwordx2 v[20:21], v39, s[24:27], s45 offen sc1
    s_mov_b64 exec, 1
    buffer_store_dwordx2 v[36:37], v39, s[24:27], s46 offen sc1
    s_mov_b64 exec, -1
Lrs_133:
    v_mov_b32 v44, s49
    ds_write_b32 v4, v44 offset:10388
    s_setpc_b64 s[78:79]
L_chain:
    s_mov_b32 s8, s42
    s_and_b32 s9, s43, 0xffff
    s_mov_b32 s10, 0x500000
    s_mov_b32 s11, 0x20000
    s_mov_b32 s12, s52
    s_and_b32 s13, s53, 0xffff
    s_mov_b32 s14, 0x500000
    s_mov_b32 s15, 0x20000
    s_mov_b32 s16, s44
    s_and_b32 s17, s45, 0xffff
    s_mov_b32 s18, 0x500000
    s_mov_b32 s19, 0x20000
    s_mov_b32 s20, s54
    s_and_b32 s21, s55, 0xffff
    s_mov_b32 s22, 0x500000
    s_mov_b32 s23, 0x20000
    s_mov_b32 s32, s56
    s_and_b32 s33, s57, 0xffff
    s_mov_b32 s34, 0x1400
    s_mov_b32 s35, 0x20000
    s_mov_b32 s84, s36
    s_and_b32 s85, s37, 0xffff
    s_mov_b32 s86, 0x1400
    s_mov_b32 s87, 0x20000
    s_and_b32 s36, s2, 7
    s_and_b32 s37, s5, 3
    s_andn2_b32 s5, s5, 3
    s_add_u32 s5, s5, s3
    s_mul_i32 s40, s37, 1310720
    s_lshl_b32 s44, s5, 8
    s_add_u32 s40, s40, s44
    s_mul_i32 s52, s3, 36864
    s_lshl_b32 s44, s3, 14
    v_lshlrev_b32 v16, 3, v2
    v_add_u32 v16, s44, v16
    v_min_u32 v16, 0x6fb4, v16
    v_mov_b32 v21, s91
    v_add_co_u32 v20, vcc, s90, v16
    s_nop 1
    v_addc_co_u32 v21, vcc, 0, v21, vcc
    global_load_dword v22, v[20:21], off
    v_lshlrev_b32 v16, 3, v2
    v_add_u32 v16, s44, v16
    v_add_u32 v16, 8192, v16
    v_min_u32 v16, 0x6fb4, v16
    v_mov_b32 v21, s91
    v_add_co_u32 v20, vcc, s90, v16
    s_nop 1
    v_addc_co_u32 v21, vcc, 0, v21, vcc
    global_load_dword v22, v[20:21], off
    v_mov_b32 v16, 0
    v_lshl_add_u32 v17, v7, 2, v4
    ds_write_b32 v17, v16 offset:8192
    v_and_b32 v15, 1, v12
    v_lshlrev_b32 v15, 4, v15
    v_mov_b32 v16, 0xffff
    v_lshlrev_b32 v16, v15, v16
    v_bfe_u32 v15, v14, 1, 2
    v_cmp_eq_u32 vcc, 0, v15
    s_nop 1
    v_cndmask_b32 v8, 0, v16, vcc
    v_cmp_eq_u32 vcc, 1, v15
    s_nop 1
    v_cndmask_b32 v9, 0, v16, vcc
    v_cmp_eq_u32 vcc, 2, v15
    s_nop 1
    v_cndmask_b32 v10, 0, v16, vcc
    v_cmp_eq_u32 vcc, 3, v15
    s_nop 1
    v_cndmask_b32 v11, 0, v16, vcc
    s_mov_b32 s43, 1048576
    s_mov_b32 s7, 0
    s_mov_b32 s51, 0
    s_lshl_b32 s50, s3, 8
    s_add_u32 s50, s50, 162816
    s_mov_b32 s38, 0
    s_mov_b32 s62, 0x05040100
    s_mov_b32 s63, 0x07060302
    s_mov_b32 s64, 0x00010001
    s_mov_b32 s65, 0x00010001
    s_movk_i32 s66, 0x1f0
    v_mov_b32 v24, -1
    v_mov_b32 v25, -1
    v_mov_b32 v26, -1
    v_mov_b32 v27, -1
    s_lshl_b32 s44, s2, 2
    s_add_u32 s44, s44, s3
    s_lshl_b32 s44, s44, 12
    buffer_store_dwordx4 v[24:27], v2, s[24:27], s44 offen offset:0 sc1
    buffer_store_dwordx4 v[24:27], v2, s[24:27], s44 offen offset:1024 sc1
    buffer_store_dwordx4 v[24:27], v2, s[24:27], s44 offen offset:2048 sc1
    buffer_store_dwordx4 v[24:27], v2, s[24:27], s44 offen offset:3072 sc1
    v_bfe_u32 v18, v2, 4, 2
    v_mul_u32_u24 v16, 40, v18
    v_bfe_u32 v18, v2, 6, 1
    v_add3_u32 v17, v16, v18, 8
    v_bfe_u32 v18, v2, 6, 2
    v_add_u32 v16, v16, v18
    v_lshrrev_b32 v18, 8, v2
    v_mad_u32_u24 v17, v18, 10, v17
    v_lshrrev_b32 v18, 9, v2
    v_mad_u32_u24 v16, v18, 20, v16
    v_bfe_u32 v18, v2, 8, 1
    v_lshl_add_u32 v16, v18, 2, v16
    v_lshlrev_b32 v16, 1, v16
    v_lshlrev_b32 v17, 1, v17
    s_mul_i32 s44, s37, 320
    buffer_load_ushort v208, v16, s[84:87], s44 offen offset:0
    buffer_load_ushort v209, v16, s[84:87], s44 offen offset:20
    buffer_load_ushort v210, v17, s[84:87], s44 offen offset:0
    buffer_load_ushort v211, v16, s[84:87], s44 offen offset:1280
    buffer_load_ushort v212, v16, s[84:87], s44 offen offset:1300
    buffer_load_ushort v213, v17, s[84:87], s44 offen offset:1280
    buffer_load_ushort v214, v16, s[84:87], s44 offen offset:2560
    buffer_load_ushort v215, v16, s[84:87], s44 offen offset:2580
    buffer_load_ushort v216, v17, s[84:87], s44 offen offset:2560
    buffer_load_ushort v217, v16, s[84:87], s44 offen offset:3840
    buffer_load_ushort v218, v16, s[84:87], s44 offen offset:3860
    buffer_load_ushort v219, v17, s[84:87], s44 offen offset:3840
    v_lshrrev_b32 v17, 8, v2
    v_mul_u32_u24 v16, 10, v17
    v_bfe_u32 v17, v2, 7, 1
    v_lshl_add_u32 v16, v17, 0, v16
    v_and_b32 v17, 0x70, v2
    v_lshl_add_u32 v16, v16, 13, v17
    s_add_u32 s39, s40, 65536
    buffer_load_dwordx4 a[112:115], v16, s[8:11], s39 offen
    s_add_u32 s39, s40, 65664
    buffer_load_dwordx4 a[116:119], v16, s[8:11], s39 offen
    s_add_u32 s39, s40, 393216
    buffer_load_dwordx4 a[120:123], v16, s[8:11], s39 offen
    s_add_u32 s39, s40, 393344
    buffer_load_dwordx4 a[124:127], v16, s[8:11], s39 offen
    s_add_u32 s39, s40, 720896
    buffer_load_dwordx4 a[128:131], v16, s[8:11], s39 offen
    s_add_u32 s39, s40, 721024
    buffer_load_dwordx4 a[132:135], v16, s[8:11], s39 offen
    s_add_u32 s39, s40, 1048576
    buffer_load_dwordx4 a[136:139], v16, s[8:11], s39 offen
    s_add_u32 s39, s40, 1048704
    buffer_load_dwordx4 a[140:143], v16, s[8:11], s39 offen
    s_waitcnt lgkmcnt(0)
    s_barrier
    v_mov_b32 v28, 1
    v_mov_b32 v29, s83
    v_mov_b32 v30, 0
    s_waitcnt vmcnt(20)
    s_mov_b64 exec, 1
    ds_add_rtn_u32 v28, v4, v28 offset:8200
    s_waitcnt lgkmcnt(0)
    v_readfirstlane_b32 s44, v28
    s_nop 0
    s_cmp_lg_u32 s44, 3
    s_cbranch_scc1 Lcl_134
    buffer_store_byte v29, v30, s[28:31], s4 offen sc1
Lcl_134:
    s_mov_b64 exec, -1
    v_lshrrev_b32 v17, 8, v2
    v_lshrrev_b32 v16, 1, v17
    v_mul_u32_u24 v16, 20, v16
    v_and_b32 v17, 1, v17
    v_lshl_add_u32 v16, v17, 2, v16
    v_bfe_u32 v17, v2, 7, 1
    v_lshl_add_u32 v16, v17, 1, v16
    v_and_b32 v17, 0x70, v2
    v_lshl_add_u32 v16, v16, 13, v17
    s_add_u32 s39, s40, 0
    s_add_u32 m0, s52, 0
    s_nop 0
    buffer_load_dwordx4 v16, s[8:11], s39 offen lds
    s_add_u32 s39, s40, 128
    s_add_u32 m0, s52, 1024
    s_nop 0
    buffer_load_dwordx4 v16, s[8:11], s39 offen lds
    s_add_u32 s39, s40, 327680
    s_add_u32 m0, s52, 2048
    s_nop 0
    buffer_load_dwordx4 v16, s[8:11], s39 offen lds
    s_add_u32 s39, s40, 327808
    s_add_u32 m0, s52, 3072
    s_nop 0
    buffer_load_dwordx4 v16, s[8:11], s39 offen lds
    s_add_u32 s39, s40, 655360
    buffer_load_dwordx4 a[0:3], v16, s[8:11], s39 offen
    s_add_u32 s39, s40, 655488
    s_add_u32 m0, s52, 4096
    s_nop 0
    buffer_load_dwordx4 v16, s[8:11], s39 offen lds
    s_add_u32 s39, s40, 983040
    buffer_load_dwordx4 a[4:7], v16, s[8:11], s39 offen
    s_add_u32 s39, s40, 983168
    s_add_u32 m0, s52, 5120
    s_nop 0
    buffer_load_dwordx4 v16, s[8:11], s39 offen lds
    s_add_u32 s39, s40, 8192
    buffer_load_dwordx4 a[8:11], v16, s[8:11], s39 offen
    s_add_u32 s39, s40, 8320
    s_add_u32 m0, s52, 6144
    s_nop 0
    buffer_load_dwordx4 v16, s[8:11], s39 offen lds
    s_add_u32 s39, s40, 335872
    buffer_load_dwordx4 a[12:15], v16, s[8:11], s39 offen
    s_add_u32 s39, s40, 336000
    s_add_u32 m0, s52, 7168
    s_nop 0
    buffer_load_dwordx4 v16, s[8:11], s39 offen lds
    s_add_u32 s39, s40, 663552
    buffer_load_dwordx4 a[16:19], v16, s[8:11], s39 offen
    s_add_u32 s39, s40, 663680
    s_add_u32 m0, s52, 8192
    s_nop 0
    buffer_load_dwordx4 v16, s[8:11], s39 offen lds
    s_add_u32 s39, s40, 991232
    buffer_load_dwordx4 a[20:23], v16, s[8:11], s39 offen
    s_add_u32 s39, s40, 991360
    s_add_u32 m0, s52, 9216
    s_nop 0
    buffer_load_dwordx4 v16, s[8:11], s39 offen lds
    s_add_u32 s39, s40, 81920
    buffer_load_dwordx4 a[24:27], v16, s[8:11], s39 offen
    s_add_u32 s39, s40, 82048
    s_add_u32 m0, s52, 10240
    s_nop 0
    buffer_load_dwordx4 v16, s[8:11], s39 offen lds
    s_add_u32 s39, s40, 409600
    buffer_load_dwordx4 a[28:31], v16, s[8:11], s39 offen
    s_add_u32 s39, s40, 409728
    s_add_u32 m0, s52, 11264
    s_nop 0
    buffer_load_dwordx4 v16, s[8:11], s39 offen lds
    s_add_u32 s39, s40, 737280
    buffer_load_dwordx4 a[32:35], v16, s[8:11], s39 offen
    s_add_u32 s39, s40, 737408
    s_add_u32 m0, s52, 12288
    s_nop 0
    buffer_load_dwordx4 v16, s[8:11], s39 offen lds
    s_add_u32 s39, s40, 1064960
    buffer_load_dwordx4 a[36:39], v16, s[8:11], s39 offen
    s_add_u32 s39, s40, 1065088
    s_add_u32 m0, s52, 13312
    s_nop 0
    buffer_load_dwordx4 v16, s[8:11], s39 offen lds
    s_add_u32 s39, s40, 90112
    buffer_load_dwordx4 a[40:43], v16, s[8:11], s39 offen
    s_add_u32 s39, s40, 90240
    s_add_u32 m0, s52, 14336
    s_nop 0
    buffer_load_dwordx4 v16, s[8:11], s39 offen lds
    s_add_u32 s39, s40, 417792
    buffer_load_dwordx4 a[44:47], v16, s[8:11], s39 offen
    s_add_u32 s39, s40, 417920
    s_add_u32 m0, s52, 15360
    s_nop 0
    buffer_load_dwordx4 v16, s[8:11], s39 offen lds
    s_add_u32 s39, s40, 745472
    buffer_load_dwordx4 a[48:51], v16, s[8:11], s39 offen
    s_add_u32 s39, s40, 745600
    s_add_u32 m0, s52, 16384
    s_nop 0
    buffer_load_dwordx4 v16, s[8:11], s39 offen lds
    s_add_u32 s39, s40, 1073152
    buffer_load_dwordx4 a[52:55], v16, s[8:11], s39 offen
    s_add_u32 s39, s40, 1073280
    s_add_u32 m0, s52, 17408
    s_nop 0
    buffer_load_dwordx4 v16, s[8:11], s39 offen lds
    s_waitcnt vmcnt(0)
    s_cmp_lg_u32 s3, 0
    s_cbranch_scc1 L_cfl
    s_mov_b32 s42, 0
Lfw_135:
    v_lshrrev_b32 v16, 2, v2
    buffer_load_dword v20, v16, s[28:31], 0 offen sc1
    s_waitcnt vmcnt(0)
Lfc_137:
    s_mul_i32 s44, s83, 0x01010101
    v_cmp_ne_u32 s[46:47], s44, v20
    v_and_b32 v20, 0x40404040, v20
    v_cmp_ne_u32 vcc, 0x40404040, v20
    s_nop 0
    s_cbranch_vccz Lfo_136
    s_sleep 32
    s_add_u32 s42, s42, 1
    s_cmp_lt_u32 s42, s43
    s_cbranch_scc1 Lfw_135
    s_mov_b32 s43, 0
Lfo_136:
    s_and_b32 s44, s2, 7
    s_lshl_b32 s44, s44, 3
    s_lshr_b64 s[46:47], s[46:47], s44
    s_and_b32 s46, s46, 0xff
    s_cselect_b32 s51, 0, 1
    v_mov_b32 v16, s51
    ds_write_b32 v4, v16 offset:8204
    s_waitcnt lgkmcnt(0)
L_cfl:
    s_barrier
    ds_read_b32 v16, v4 offset:8204
    s_waitcnt lgkmcnt(0)
    v_readfirstlane_b32 s51, v16
    v_lshrrev_b32 v16, 8, v2
    v_mul_u32_u24 v5, 10240, v16
    v_bfe_u32 v16, v2, 4, 4
    v_mad_u32_u24 v5, v16, 20, v5
    v_lshrrev_b32 v3, 1, v2
    v_add_u32 v3, 0x25800, v3
    v_lshl_or_b32 v40, v209, 16, v208
    v_lshl_or_b32 v41, v210, 16, v210
    ds_write_b64 v3, v[40:41] offset:0
    v_lshl_or_b32 v40, v212, 16, v211
    v_lshl_or_b32 v41, v213, 16, v213
    ds_write_b64 v3, v[40:41] offset:512
    v_lshl_or_b32 v40, v215, 16, v214
    v_lshl_or_b32 v41, v216, 16, v216
    ds_write_b64 v3, v[40:41] offset:1024
    v_lshl_or_b32 v40, v218, 16, v217
    v_lshl_or_b32 v41, v219, 16, v219
    ds_write_b64 v3, v[40:41] offset:1536
    v_lshrrev_b32 v17, 8, v2
    v_lshrrev_b32 v7, 1, v17
    v_mul_u32_u24 v7, 20, v7
    v_and_b32 v17, 1, v17
    v_lshl_add_u32 v7, v17, 2, v7
    v_bfe_u32 v17, v2, 7, 1
    v_lshl_add_u32 v7, v17, 1, v7
    v_and_b32 v17, 0x70, v2
    v_lshl_add_u32 v7, v7, 13, v17
    s_mul_i32 s44, s5, 163840
    s_mul_i32 s45, s37, 320
    s_add_u32 s44, s44, s45
    s_add_u32 s45, s44, 0
    buffer_load_dwordx4 v[208:211], v5, s[16:19], s45 offen
    buffer_load_dword v240, v5, s[16:19], s45 offen offset:16
    s_add_u32 s45, s44, 1280
    buffer_load_dwordx4 v[212:215], v5, s[16:19], s45 offen
    buffer_load_dword v241, v5, s[16:19], s45 offen offset:16
    s_add_u32 s45, s44, 2560
    buffer_load_dwordx4 v[216:219], v5, s[16:19], s45 offen
    buffer_load_dword v242, v5, s[16:19], s45 offen offset:16
    s_add_u32 s45, s44, 3840
    buffer_load_dwordx4 v[220:223], v5, s[16:19], s45 offen
    buffer_load_dword v243, v5, s[16:19], s45 offen offset:16
    s_add_u32 s45, s44, 5120
    buffer_load_dwordx4 v[224:227], v5, s[16:19], s45 offen
    buffer_load_dword v244, v5, s[16:19], s45 offen offset:16
    s_add_u32 s45, s44, 6400
    buffer_load_dwordx4 v[228:231], v5, s[16:19], s45 offen
    buffer_load_dword v245, v5, s[16:19], s45 offen offset:16
    s_add_u32 s45, s44, 7680
    buffer_load_dwordx4 v[232:235], v5, s[16:19], s45 offen
    buffer_load_dword v246, v5, s[16:19], s45 offen offset:16
    s_add_u32 s45, s44, 8960
    buffer_load_dwordx4 v[236:239], v5, s[16:19], s45 offen
    buffer_load_dword v247, v5, s[16:19], s45 offen offset:16
    s_add_u32 s39, s40, 0
    s_add_u32 m0, s52, 18432
    s_nop 0
    buffer_load_dwordx4 v7, s[12:15], s39 offen lds
    s_add_u32 s39, s40, 128
    s_add_u32 m0, s52, 19456
    s_nop 0
    buffer_load_dwordx4 v7, s[12:15], s39 offen lds
    s_add_u32 s39, s40, 327680
    s_add_u32 m0, s52, 20480
    s_nop 0
    buffer_load_dwordx4 v7, s[12:15], s39 offen lds
    s_add_u32 s39, s40, 327808
    s_add_u32 m0, s52, 21504
    s_nop 0
    buffer_load_dwordx4 v7, s[12:15], s39 offen lds
    s_add_u32 s39, s40, 655360
    buffer_load_dwordx4 a[56:59], v7, s[12:15], s39 offen
    s_add_u32 s39, s40, 655488
    s_add_u32 m0, s52, 22528
    s_nop 0
    buffer_load_dwordx4 v7, s[12:15], s39 offen lds
    s_add_u32 s39, s40, 983040
    buffer_load_dwordx4 a[60:63], v7, s[12:15], s39 offen
    s_add_u32 s39, s40, 983168
    s_add_u32 m0, s52, 23552
    s_nop 0
    buffer_load_dwordx4 v7, s[12:15], s39 offen lds
    ds_read_b64 v[40:41], v3 offset:0
    s_mov_b32 s49, 0
    s_waitcnt lgkmcnt(0)
    s_call_b64 s[78:79], S_D
    v_mov_b32 v40, 0x3f803f80
    v_mov_b32 v41, 0x3f803f80
    s_lshl_b32 s45, s5, 2
    s_add_u32 s45, s45, s37
    s_lshl_b32 s45, s45, 9
    s_add_u32 s45, s45, 3571712
    s_mov_b32 s46, 8388608
    s_mov_b32 s49, 0
    s_call_b64 s[78:79], S_D2
    s_waitcnt vmcnt(12)
    v_perm_b32 v48, v212, v208, s62
    v_perm_b32 v64, v212, v208, s63
    v_perm_b32 v80, v213, v209, s62
    v_perm_b32 v96, v213, v209, s63
    v_perm_b32 v112, v214, v210, s62
    v_perm_b32 v128, v214, v210, s63
    v_perm_b32 v144, v215, v211, s62
    v_perm_b32 v160, v215, v211, s63
    v_perm_b32 v176, v241, v240, s62
    v_perm_b32 v192, v241, v240, s63
    v_perm_b32 v49, v220, v216, s62
    v_perm_b32 v65, v220, v216, s63
    v_perm_b32 v81, v221, v217, s62
    v_perm_b32 v97, v221, v217, s63
    v_perm_b32 v113, v222, v218, s62
    v_perm_b32 v129, v222, v218, s63
    v_perm_b32 v145, v223, v219, s62
    v_perm_b32 v161, v223, v219, s63
    v_perm_b32 v177, v243, v242, s62
    v_perm_b32 v193, v243, v242, s63
    v_perm_b32 v50, v228, v224, s62
    v_perm_b32 v66, v228, v224, s63
    v_perm_b32 v82, v229, v225, s62
    v_perm_b32 v98, v229, v225, s63
    v_perm_b32 v114, v230, v226, s62
    v_perm_b32 v130, v230, v226, s63
    v_perm_b32 v146, v231, v227, s62
    v_perm_b32 v162, v231, v227, s63
    v_perm_b32 v178, v245, v244, s62
    v_perm_b32 v194, v245, v244, s63
    v_perm_b32 v51, v236, v232, s62
    v_perm_b32 v67, v236, v232, s63
    v_perm_b32 v83, v237, v233, s62
    v_perm_b32 v99, v237, v233, s63
    v_perm_b32 v115, v238, v234, s62
    v_perm_b32 v131, v238, v234, s63
    v_perm_b32 v147, v239, v235, s62
    v_perm_b32 v163, v239, v235, s63
    v_perm_b32 v179, v247, v246, s62
    v_perm_b32 v195, v247, v246, s63
    s_mul_i32 s44, s5, 163840
    s_mul_i32 s45, s37, 320
    s_add_u32 s44, s44, s45
    s_add_u32 s45, s44, 40960
    buffer_load_dwordx4 v[208:211], v5, s[16:19], s45 offen
    buffer_load_dword v240, v5, s[16:19], s45 offen offset:16
    s_add_u32 s45, s44, 42240
    buffer_load_dwordx4 v[212:215], v5, s[16:19], s45 offen
    buffer_load_dword v241, v5, s[16:19], s45 offen offset:16
    s_add_u32 s45, s44, 43520
    buffer_load_dwordx4 v[216:219], v5, s[16:19], s45 offen
    buffer_load_dword v242, v5, s[16:19], s45 offen offset:16
    s_add_u32 s45, s44, 44800
    buffer_load_dwordx4 v[220:223], v5, s[16:19], s45 offen
    buffer_load_dword v243, v5, s[16:19], s45 offen offset:16
    s_add_u32 s45, s44, 46080
    buffer_load_dwordx4 v[224:227], v5, s[16:19], s45 offen
    buffer_load_dword v244, v5, s[16:19], s45 offen offset:16
    s_add_u32 s45, s44, 47360
    buffer_load_dwordx4 v[228:231], v5, s[16:19], s45 offen
    buffer_load_dword v245, v5, s[16:19], s45 offen offset:16
    s_add_u32 s45, s44, 48640
    buffer_load_dwordx4 v[232:235], v5, s[16:19], s45 offen
    buffer_load_dword v246, v5, s[16:19], s45 offen offset:16
    s_add_u32 s45, s44, 49920
    buffer_load_dwordx4 v[236:239], v5, s[16:19], s45 offen
    buffer_load_dword v247, v5, s[16:19], s45 offen offset:16
    s_add_u32 s39, s40, 8192
    buffer_load_dwordx4 a[64:67], v7, s[12:15], s39 offen
    s_add_u32 s39, s40, 8320
    s_add_u32 m0, s52, 24576
    s_nop 0
    buffer_load_dwordx4 v7, s[12:15], s39 offen lds
    s_add_u32 s39, s40, 335872
    buffer_load_dwordx4 a[68:71], v7, s[12:15], s39 offen
    s_add_u32 s39, s40, 336000
    s_add_u32 m0, s52, 25600
    s_nop 0
    buffer_load_dwordx4 v7, s[12:15], s39 offen lds
    s_add_u32 s39, s40, 663552
    buffer_load_dwordx4 a[72:75], v7, s[12:15], s39 offen
    s_add_u32 s39, s40, 663680
    s_add_u32 m0, s52, 26624
    s_nop 0
    buffer_load_dwordx4 v7, s[12:15], s39 offen lds
    s_add_u32 s39, s40, 991232
    buffer_load_dwordx4 a[76:79], v7, s[12:15], s39 offen
    s_add_u32 s39, s40, 991360
    s_add_u32 m0, s52, 27648
    s_nop 0
    buffer_load_dwordx4 v7, s[12:15], s39 offen lds
    ds_read_b64 v[40:41], v3 offset:512
    s_mov_b32 s49, 4
    s_waitcnt lgkmcnt(0)
    s_call_b64 s[78:79], S_D
    s_waitcnt vmcnt(10)
    v_perm_b32 v52, v212, v208, s62
    v_perm_b32 v68, v212, v208, s63
    v_perm_b32 v84, v213, v209, s62
    v_perm_b32 v100, v213, v209, s63
    v_perm_b32 v116, v214, v210, s62
    v_perm_b32 v132, v214, v210, s63
    v_perm_b32 v148, v215, v211, s62
    v_perm_b32 v164, v215, v211, s63
    v_perm_b32 v180, v241, v240, s62
    v_perm_b32 v196, v241, v240, s63
    v_perm_b32 v53, v220, v216, s62
    v_perm_b32 v69, v220, v216, s63
    v_perm_b32 v85, v221, v217, s62
    v_perm_b32 v101, v221, v217, s63
    v_perm_b32 v117, v222, v218, s62
    v_perm_b32 v133, v222, v218, s63
    v_perm_b32 v149, v223, v219, s62
    v_perm_b32 v165, v223, v219, s63
    v_perm_b32 v181, v243, v242, s62
    v_perm_b32 v197, v243, v242, s63
    v_perm_b32 v54, v228, v224, s62
    v_perm_b32 v70, v228, v224, s63
    v_perm_b32 v86, v229, v225, s62
    v_perm_b32 v102, v229, v225, s63
    v_perm_b32 v118, v230, v226, s62
    v_perm_b32 v134, v230, v226, s63
    v_perm_b32 v150, v231, v227, s62
    v_perm_b32 v166, v231, v227, s63
    v_perm_b32 v182, v245, v244, s62
    v_perm_b32 v198, v245, v244, s63
    v_perm_b32 v55, v236, v232, s62
    v_perm_b32 v71, v236, v232, s63
    v_perm_b32 v87, v237, v233, s62
    v_perm_b32 v103, v237, v233, s63
    v_perm_b32 v119, v238, v234, s62
    v_perm_b32 v135, v238, v234, s63
    v_perm_b32 v151, v239, v235, s62
    v_perm_b32 v167, v239, v235, s63
    v_perm_b32 v183, v247, v246, s62
    v_perm_b32 v199, v247, v246, s63
    s_mul_i32 s44, s5, 163840
    s_mul_i32 s45, s37, 320
    s_add_u32 s44, s44, s45
    s_add_u32 s45, s44, 81920
    buffer_load_dwordx4 v[208:211], v5, s[16:19], s45 offen
    buffer_load_dword v240, v5, s[16:19], s45 offen offset:16
    s_add_u32 s45, s44, 83200
    buffer_load_dwordx4 v[212:215], v5, s[16:19], s45 offen
    buffer_load_dword v241, v5, s[16:19], s45 offen offset:16
    s_add_u32 s45, s44, 84480
    buffer_load_dwordx4 v[216:219], v5, s[16:19], s45 offen
    buffer_load_dword v242, v5, s[16:19], s45 offen offset:16
    s_add_u32 s45, s44, 85760
    buffer_load_dwordx4 v[220:223], v5, s[16:19], s45 offen
    buffer_load_dword v243, v5, s[16:19], s45 offen offset:16
    s_add_u32 s45, s44, 87040
    buffer_load_dwordx4 v[224:227], v5, s[16:19], s45 offen
    buffer_load_dword v244, v5, s[16:19], s45 offen offset:16
    s_add_u32 s45, s44, 88320
    buffer_load_dwordx4 v[228:231], v5, s[16:19], s45 offen
    buffer_load_dword v245, v5, s[16:19], s45 offen offset:16
    s_add_u32 s45, s44, 89600
    buffer_load_dwordx4 v[232:235], v5, s[16:19], s45 offen
    buffer_load_dword v246, v5, s[16:19], s45 offen offset:16
    s_add_u32 s45, s44, 90880
    buffer_load_dwordx4 v[236:239], v5, s[16:19], s45 offen
    buffer_load_dword v247, v5, s[16:19], s45 offen offset:16
    s_add_u32 s39, s40, 81920
    buffer_load_dwordx4 a[80:83], v7, s[12:15], s39 offen
    s_add_u32 s39, s40, 82048
    s_add_u32 m0, s52, 28672
    s_nop 0
    buffer_load_dwordx4 v7, s[12:15], s39 offen lds
    s_add_u32 s39, s40, 409600
    buffer_load_dwordx4 a[84:87], v7, s[12:15], s39 offen
    s_add_u32 s39, s40, 409728
    s_add_u32 m0, s52, 29696
    s_nop 0
    buffer_load_dwordx4 v7, s[12:15], s39 offen lds
    s_add_u32 s39, s40, 737280
    buffer_load_dwordx4 a[88:91], v7, s[12:15], s39 offen
    s_add_u32 s39, s40, 737408
    s_add_u32 m0, s52, 30720
    s_nop 0
    buffer_load_dwordx4 v7, s[12:15], s39 offen lds
    s_add_u32 s39, s40, 1064960
    buffer_load_dwordx4 a[92:95], v7, s[12:15], s39 offen
    s_add_u32 s39, s40, 1065088
    s_add_u32 m0, s52, 31744
    s_nop 0
    buffer_load_dwordx4 v7, s[12:15], s39 offen lds
    ds_read_b64 v[40:41], v3 offset:1024
    s_mov_b32 s49, 8
    s_waitcnt lgkmcnt(0)
    s_call_b64 s[78:79], S_D
    s_waitcnt vmcnt(10)
    v_perm_b32 v56, v212, v208, s62
    v_perm_b32 v72, v212, v208, s63
    v_perm_b32 v88, v213, v209, s62
    v_perm_b32 v104, v213, v209, s63
    v_perm_b32 v120, v214, v210, s62
    v_perm_b32 v136, v214, v210, s63
    v_perm_b32 v152, v215, v211, s62
    v_perm_b32 v168, v215, v211, s63
    v_perm_b32 v184, v241, v240, s62
    v_perm_b32 v200, v241, v240, s63
    v_perm_b32 v57, v220, v216, s62
    v_perm_b32 v73, v220, v216, s63
    v_perm_b32 v89, v221, v217, s62
    v_perm_b32 v105, v221, v217, s63
    v_perm_b32 v121, v222, v218, s62
    v_perm_b32 v137, v222, v218, s63
    v_perm_b32 v153, v223, v219, s62
    v_perm_b32 v169, v223, v219, s63
    v_perm_b32 v185, v243, v242, s62
    v_perm_b32 v201, v243, v242, s63
    v_perm_b32 v58, v228, v224, s62
    v_perm_b32 v74, v228, v224, s63
    v_perm_b32 v90, v229, v225, s62
    v_perm_b32 v106, v229, v225, s63
    v_perm_b32 v122, v230, v226, s62
    v_perm_b32 v138, v230, v226, s63
    v_perm_b32 v154, v231, v227, s62
    v_perm_b32 v170, v231, v227, s63
    v_perm_b32 v186, v245, v244, s62
    v_perm_b32 v202, v245, v244, s63
    v_perm_b32 v59, v236, v232, s62
    v_perm_b32 v75, v236, v232, s63
    v_perm_b32 v91, v237, v233, s62
    v_perm_b32 v107, v237, v233, s63
    v_perm_b32 v123, v238, v234, s62
    v_perm_b32 v139, v238, v234, s63
    v_perm_b32 v155, v239, v235, s62
    v_perm_b32 v171, v239, v235, s63
    v_perm_b32 v187, v247, v246, s62
    v_perm_b32 v203, v247, v246, s63
    s_mul_i32 s44, s5, 163840
    s_mul_i32 s45, s37, 320
    s_add_u32 s44, s44, s45
    s_add_u32 s45, s44, 122880
    buffer_load_dwordx4 v[208:211], v5, s[16:19], s45 offen
    buffer_load_dword v240, v5, s[16:19], s45 offen offset:16
    s_add_u32 s45, s44, 124160
    buffer_load_dwordx4 v[212:215], v5, s[16:19], s45 offen
    buffer_load_dword v241, v5, s[16:19], s45 offen offset:16
    s_add_u32 s45, s44, 125440
    buffer_load_dwordx4 v[216:219], v5, s[16:19], s45 offen
    buffer_load_dword v242, v5, s[16:19], s45 offen offset:16
    s_add_u32 s45, s44, 126720
    buffer_load_dwordx4 v[220:223], v5, s[16:19], s45 offen
    buffer_load_dword v243, v5, s[16:19], s45 offen offset:16
    s_add_u32 s45, s44, 128000
    buffer_load_dwordx4 v[224:227], v5, s[16:19], s45 offen
    buffer_load_dword v244, v5, s[16:19], s45 offen offset:16
    s_add_u32 s45, s44, 129280
    buffer_load_dwordx4 v[228:231], v5, s[16:19], s45 offen
    buffer_load_dword v245, v5, s[16:19], s45 offen offset:16
    s_add_u32 s45, s44, 130560
    buffer_load_dwordx4 v[232:235], v5, s[16:19], s45 offen
    buffer_load_dword v246, v5, s[16:19], s45 offen offset:16
    s_add_u32 s45, s44, 131840
    buffer_load_dwordx4 v[236:239], v5, s[16:19], s45 offen
    buffer_load_dword v247, v5, s[16:19], s45 offen offset:16
    s_add_u32 s39, s40, 90112
    buffer_load_dwordx4 a[96:99], v7, s[12:15], s39 offen
    s_add_u32 s39, s40, 90240
    s_add_u32 m0, s52, 32768
    s_nop 0
    buffer_load_dwordx4 v7, s[12:15], s39 offen lds
    s_add_u32 s39, s40, 417792
    buffer_load_dwordx4 a[100:103], v7, s[12:15], s39 offen
    s_add_u32 s39, s40, 417920
    s_add_u32 m0, s52, 33792
    s_nop 0
    buffer_load_dwordx4 v7, s[12:15], s39 offen lds
    s_add_u32 s39, s40, 745472
    buffer_load_dwordx4 a[104:107], v7, s[12:15], s39 offen
    s_add_u32 s39, s40, 745600
    s_add_u32 m0, s52, 34816
    s_nop 0
    buffer_load_dwordx4 v7, s[12:15], s39 offen lds
    s_add_u32 s39, s40, 1073152
    buffer_load_dwordx4 a[108:111], v7, s[12:15], s39 offen
    s_add_u32 s39, s40, 1073280
    s_add_u32 m0, s52, 35840
    s_nop 0
    buffer_load_dwordx4 v7, s[12:15], s39 offen lds
    ds_read_b64 v[40:41], v3 offset:1536
    s_mov_b32 s49, 12
    s_waitcnt lgkmcnt(0)
    s_call_b64 s[78:79], S_D
    s_waitcnt vmcnt(10)
    v_perm_b32 v60, v212, v208, s62
    v_perm_b32 v76, v212, v208, s63
    v_perm_b32 v92, v213, v209, s62
    v_perm_b32 v108, v213, v209, s63
    v_perm_b32 v124, v214, v210, s62
    v_perm_b32 v140, v214, v210, s63
    v_perm_b32 v156, v215, v211, s62
    v_perm_b32 v172, v215, v211, s63
    v_perm_b32 v188, v241, v240, s62
    v_perm_b32 v204, v241, v240, s63
    v_perm_b32 v61, v220, v216, s62
    v_perm_b32 v77, v220, v216, s63
    v_perm_b32 v93, v221, v217, s62
    v_perm_b32 v109, v221, v217, s63
    v_perm_b32 v125, v222, v218, s62
    v_perm_b32 v141, v222, v218, s63
    v_perm_b32 v157, v223, v219, s62
    v_perm_b32 v173, v223, v219, s63
    v_perm_b32 v189, v243, v242, s62
    v_perm_b32 v205, v243, v242, s63
    v_perm_b32 v62, v228, v224, s62
    v_perm_b32 v78, v228, v224, s63
    v_perm_b32 v94, v229, v225, s62
    v_perm_b32 v110, v229, v225, s63
    v_perm_b32 v126, v230, v226, s62
    v_perm_b32 v142, v230, v226, s63
    v_perm_b32 v158, v231, v227, s62
    v_perm_b32 v174, v231, v227, s63
    v_perm_b32 v190, v245, v244, s62
    v_perm_b32 v206, v245, v244, s63
    v_perm_b32 v63, v236, v232, s62
    v_perm_b32 v79, v236, v232, s63
    v_perm_b32 v95, v237, v233, s62
    v_perm_b32 v111, v237, v233, s63
    v_perm_b32 v127, v238, v234, s62
    v_perm_b32 v143, v238, v234, s63
    v_perm_b32 v159, v239, v235, s62
    v_perm_b32 v175, v239, v235, s63
    v_perm_b32 v191, v247, v246, s62
    v_perm_b32 v207, v247, v246, s63
    v_lshrrev_b32 v17, 8, v2
    v_mul_u32_u24 v16, 10, v17
    v_bfe_u32 v17, v2, 7, 1
    v_lshl_add_u32 v16, v17, 0, v16
    v_and_b32 v17, 0x70, v2
    v_lshl_add_u32 v16, v16, 13, v17
    s_add_u32 s39, s40, 65536
    buffer_load_dwordx4 a[112:115], v16, s[12:15], s39 offen
    s_add_u32 s39, s40, 65664
    buffer_load_dwordx4 a[116:119], v16, s[12:15], s39 offen
    s_add_u32 s39, s40, 393216
    buffer_load_dwordx4 a[120:123], v16, s[12:15], s39 offen
    s_add_u32 s39, s40, 393344
    buffer_load_dwordx4 a[124:127], v16, s[12:15], s39 offen
    s_add_u32 s39, s40, 720896
    buffer_load_dwordx4 a[128:131], v16, s[12:15], s39 offen
    s_add_u32 s39, s40, 721024
    buffer_load_dwordx4 a[132:135], v16, s[12:15], s39 offen
    s_add_u32 s39, s40, 1048576
    buffer_load_dwordx4 a[136:139], v16, s[12:15], s39 offen
    s_add_u32 s39, s40, 1048704
    buffer_load_dwordx4 a[140:143], v16, s[12:15], s39 offen
    s_mul_i32 s44, s5, 163840
    s_mul_i32 s45, s37, 320
    s_add_u32 s44, s44, s45
    s_add_u32 s45, s44, 0
    buffer_load_dwordx4 v[208:211], v5, s[20:23], s45 offen
    buffer_load_dword v240, v5, s[20:23], s45 offen offset:16
    s_add_u32 s45, s44, 1280
    buffer_load_dwordx4 v[212:215], v5, s[20:23], s45 offen
    buffer_load_dword v241, v5, s[20:23], s45 offen offset:16
    s_add_u32 s45, s44, 2560
    buffer_load_dwordx4 v[216:219], v5, s[20:23], s45 offen
    buffer_load_dword v242, v5, s[20:23], s45 offen offset:16
    s_add_u32 s45, s44, 3840
    buffer_load_dwordx4 v[220:223], v5, s[20:23], s45 offen
    buffer_load_dword v243, v5, s[20:23], s45 offen offset:16
    s_add_u32 s45, s44, 5120
    buffer_load_dwordx4 v[224:227], v5, s[20:23], s45 offen
    buffer_load_dword v244, v5, s[20:23], s45 offen offset:16
    s_add_u32 s45, s44, 6400
    buffer_load_dwordx4 v[228:231], v5, s[20:23], s45 offen
    buffer_load_dword v245, v5, s[20:23], s45 offen offset:16
    s_add_u32 s45, s44, 7680
    buffer_load_dwordx4 v[232:235], v5, s[20:23], s45 offen
    buffer_load_dword v246, v5, s[20:23], s45 offen offset:16
    s_add_u32 s45, s44, 8960
    buffer_load_dwordx4 v[236:239], v5, s[20:23], s45 offen
    buffer_load_dword v247, v5, s[20:23], s45 offen offset:16
    s_waitcnt vmcnt(16)
    v_mov_b32 v40, 0x3f803f80
    v_mov_b32 v41, 0x3f803f80
    s_lshl_b32 s45, s5, 2
    s_add_u32 s45, s45, s37
    s_lshl_b32 s45, s45, 9
    s_add_u32 s45, s45, 3637248
    s_mov_b32 s46, 8388608
    s_mov_b32 s49, 1
    s_call_b64 s[78:79], S_D2
    s_waitcnt vmcnt(0)
    v_perm_b32 v16, v212, v208, s62
    v_accvgpr_write_b32 a144, v16
    v_perm_b32 v17, v212, v208, s63
    v_accvgpr_write_b32 a148, v17
    v_perm_b32 v16, v213, v209, s62
    v_accvgpr_write_b32 a152, v16
    v_perm_b32 v17, v213, v209, s63
    v_accvgpr_write_b32 a156, v17
    v_perm_b32 v16, v214, v210, s62
    v_accvgpr_write_b32 a160, v16
    v_perm_b32 v17, v214, v210, s63
    v_accvgpr_write_b32 a164, v17
    v_perm_b32 v16, v215, v211, s62
    v_accvgpr_write_b32 a168, v16
    v_perm_b32 v17, v215, v211, s63
    v_accvgpr_write_b32 a172, v17
    v_perm_b32 v16, v241, v240, s62
    v_accvgpr_write_b32 a176, v16
    v_perm_b32 v17, v241, v240, s63
    v_accvgpr_write_b32 a180, v17
    v_perm_b32 v16, v220, v216, s62
    v_accvgpr_write_b32 a145, v16
    v_perm_b32 v17, v220, v216, s63
    v_accvgpr_write_b32 a149, v17
    v_perm_b32 v16, v221, v217, s62
    v_accvgpr_write_b32 a153, v16
    v_perm_b32 v17, v221, v217, s63
    v_accvgpr_write_b32 a157, v17
    v_perm_b32 v16, v222, v218, s62
    v_accvgpr_write_b32 a161, v16
    v_perm_b32 v17, v222, v218, s63
    v_accvgpr_write_b32 a165, v17
    v_perm_b32 v16, v223, v219, s62
    v_accvgpr_write_b32 a169, v16
    v_perm_b32 v17, v223, v219, s63
    v_accvgpr_write_b32 a173, v17
    v_perm_b32 v16, v243, v242, s62
    v_accvgpr_write_b32 a177, v16
    v_perm_b32 v17, v243, v242, s63
    v_accvgpr_write_b32 a181, v17
    v_perm_b32 v16, v228, v224, s62
    v_accvgpr_write_b32 a146, v16
    v_perm_b32 v17, v228, v224, s63
    v_accvgpr_write_b32 a150, v17
    v_perm_b32 v16, v229, v225, s62
    v_accvgpr_write_b32 a154, v16
    v_perm_b32 v17, v229, v225, s63
    v_accvgpr_write_b32 a158, v17
    v_perm_b32 v16, v230, v226, s62
    v_accvgpr_write_b32 a162, v16
    v_perm_b32 v17, v230, v226, s63
    v_accvgpr_write_b32 a166, v17
    v_perm_b32 v16, v231, v227, s62
    v_accvgpr_write_b32 a170, v16
    v_perm_b32 v17, v231, v227, s63
    v_accvgpr_write_b32 a174, v17
    v_perm_b32 v16, v245, v244, s62
    v_accvgpr_write_b32 a178, v16
    v_perm_b32 v17, v245, v244, s63
    v_accvgpr_write_b32 a182, v17
    v_perm_b32 v16, v236, v232, s62
    v_accvgpr_write_b32 a147, v16
    v_perm_b32 v17, v236, v232, s63
    v_accvgpr_write_b32 a151, v17
    v_perm_b32 v16, v237, v233, s62
    v_accvgpr_write_b32 a155, v16
    v_perm_b32 v17, v237, v233, s63
    v_accvgpr_write_b32 a159, v17
    v_perm_b32 v16, v238, v234, s62
    v_accvgpr_write_b32 a163, v16
    v_perm_b32 v17, v238, v234, s63
    v_accvgpr_write_b32 a167, v17
    v_perm_b32 v16, v239, v235, s62
    v_accvgpr_write_b32 a171, v16
    v_perm_b32 v17, v239, v235, s63
    v_accvgpr_write_b32 a175, v17
    v_perm_b32 v16, v247, v246, s62
    v_accvgpr_write_b32 a179, v16
    v_perm_b32 v17, v247, v246, s63
    v_accvgpr_write_b32 a183, v17
    s_mul_i32 s44, s5, 163840
    s_mul_i32 s45, s37, 320
    s_add_u32 s44, s44, s45
    s_add_u32 s45, s44, 40960
    buffer_load_dwordx4 v[208:211], v5, s[20:23], s45 offen
    buffer_load_dword v240, v5, s[20:23], s45 offen offset:16
    s_add_u32 s45, s44, 42240
    buffer_load_dwordx4 v[212:215], v5, s[20:23], s45 offen
    buffer_load_dword v241, v5, s[20:23], s45 offen offset:16
    s_add_u32 s45, s44, 43520
    buffer_load_dwordx4 v[216:219], v5, s[20:23], s45 offen
    buffer_load_dword v242, v5, s[20:23], s45 offen offset:16
    s_add_u32 s45, s44, 44800
    buffer_load_dwordx4 v[220:223], v5, s[20:23], s45 offen
    buffer_load_dword v243, v5, s[20:23], s45 offen offset:16
    s_add_u32 s45, s44, 46080
    buffer_load_dwordx4 v[224:227], v5, s[20:23], s45 offen
    buffer_load_dword v244, v5, s[20:23], s45 offen offset:16
    s_add_u32 s45, s44, 47360
    buffer_load_dwordx4 v[228:231], v5, s[20:23], s45 offen
    buffer_load_dword v245, v5, s[20:23], s45 offen offset:16
    s_add_u32 s45, s44, 48640
    buffer_load_dwordx4 v[232:235], v5, s[20:23], s45 offen
    buffer_load_dword v246, v5, s[20:23], s45 offen offset:16
    s_add_u32 s45, s44, 49920
    buffer_load_dwordx4 v[236:239], v5, s[20:23], s45 offen
    buffer_load_dword v247, v5, s[20:23], s45 offen offset:16
    ds_read_b64 v[0:1], v3
    s_lshl_b32 s49, s7, 2
    s_call_b64 s[78:79], S_B
    v_mov_b32 v40, v0
    v_mov_b32 v41, v1
    s_mov_b32 s47, -1
    s_call_b64 s[78:79], S_C
    s_add_u32 s49, s49, 1
    s_call_b64 s[78:79], S_D
    v_mov_b32 v0, v40
    v_mov_b32 v1, v41
    v_lshrrev_b32 v17, 8, v2
    v_mul_u32_u24 v16, 10, v17
    v_bfe_u32 v17, v2, 7, 1
    v_lshl_add_u32 v16, v17, 0, v16
    v_and_b32 v17, 0x70, v2
    v_lshl_add_u32 v16, v16, 13, v17
    s_add_u32 s39, s40, 65536
    buffer_load_dwordx4 a[112:115], v16, s[8:11], s39 offen
    s_add_u32 s39, s40, 65664
    buffer_load_dwordx4 a[116:119], v16, s[8:11], s39 offen
    s_add_u32 s39, s40, 393216
    buffer_load_dwordx4 a[120:123], v16, s[8:11], s39 offen
    s_add_u32 s39, s40, 393344
    buffer_load_dwordx4 a[124:127], v16, s[8:11], s39 offen
    s_add_u32 s39, s40, 720896
    buffer_load_dwordx4 a[128:131], v16, s[8:11], s39 offen
    s_add_u32 s39, s40, 721024
    buffer_load_dwordx4 a[132:135], v16, s[8:11], s39 offen
    s_add_u32 s39, s40, 1048576
    buffer_load_dwordx4 a[136:139], v16, s[8:11], s39 offen
    s_add_u32 s39, s40, 1048704
    buffer_load_dwordx4 a[140:143], v16, s[8:11], s39 offen
    s_waitcnt vmcnt(0)
    v_perm_b32 v16, v212, v208, s62
    v_accvgpr_write_b32 a184, v16
    v_perm_b32 v17, v212, v208, s63
    v_accvgpr_write_b32 a188, v17
    v_perm_b32 v16, v213, v209, s62
    v_accvgpr_write_b32 a192, v16
    v_perm_b32 v17, v213, v209, s63
    v_accvgpr_write_b32 a196, v17
    v_perm_b32 v16, v214, v210, s62
    v_accvgpr_write_b32 a200, v16
    v_perm_b32 v17, v214, v210, s63
    v_accvgpr_write_b32 a204, v17
    v_perm_b32 v16, v215, v211, s62
    v_accvgpr_write_b32 a208, v16
    v_perm_b32 v17, v215, v211, s63
    v_accvgpr_write_b32 a212, v17
    v_perm_b32 v16, v241, v240, s62
    v_accvgpr_write_b32 a216, v16
    v_perm_b32 v17, v241, v240, s63
    v_accvgpr_write_b32 a220, v17
    v_perm_b32 v16, v220, v216, s62
    v_accvgpr_write_b32 a185, v16
    v_perm_b32 v17, v220, v216, s63
    v_accvgpr_write_b32 a189, v17
    v_perm_b32 v16, v221, v217, s62
    v_accvgpr_write_b32 a193, v16
    v_perm_b32 v17, v221, v217, s63
    v_accvgpr_write_b32 a197, v17
    v_perm_b32 v16, v222, v218, s62
    v_accvgpr_write_b32 a201, v16
    v_perm_b32 v17, v222, v218, s63
    v_accvgpr_write_b32 a205, v17
    v_perm_b32 v16, v223, v219, s62
    v_accvgpr_write_b32 a209, v16
    v_perm_b32 v17, v223, v219, s63
    v_accvgpr_write_b32 a213, v17
    v_perm_b32 v16, v243, v242, s62
    v_accvgpr_write_b32 a217, v16
    v_perm_b32 v17, v243, v242, s63
    v_accvgpr_write_b32 a221, v17
    v_perm_b32 v16, v228, v224, s62
    v_accvgpr_write_b32 a186, v16
    v_perm_b32 v17, v228, v224, s63
    v_accvgpr_write_b32 a190, v17
    v_perm_b32 v16, v229, v225, s62
    v_accvgpr_write_b32 a194, v16
    v_perm_b32 v17, v229, v225, s63
    v_accvgpr_write_b32 a198, v17
    v_perm_b32 v16, v230, v226, s62
    v_accvgpr_write_b32 a202, v16
    v_perm_b32 v17, v230, v226, s63
    v_accvgpr_write_b32 a206, v17
    v_perm_b32 v16, v231, v227, s62
    v_accvgpr_write_b32 a210, v16
    v_perm_b32 v17, v231, v227, s63
    v_accvgpr_write_b32 a214, v17
    v_perm_b32 v16, v245, v244, s62
    v_accvgpr_write_b32 a218, v16
    v_perm_b32 v17, v245, v244, s63
    v_accvgpr_write_b32 a222, v17
    v_perm_b32 v16, v236, v232, s62
    v_accvgpr_write_b32 a187, v16
    v_perm_b32 v17, v236, v232, s63
    v_accvgpr_write_b32 a191, v17
    v_perm_b32 v16, v237, v233, s62
    v_accvgpr_write_b32 a195, v16
    v_perm_b32 v17, v237, v233, s63
    v_accvgpr_write_b32 a199, v17
    v_perm_b32 v16, v238, v234, s62
    v_accvgpr_write_b32 a203, v16
    v_perm_b32 v17, v238, v234, s63
    v_accvgpr_write_b32 a207, v17
    v_perm_b32 v16, v239, v235, s62
    v_accvgpr_write_b32 a211, v16
    v_perm_b32 v17, v239, v235, s63
    v_accvgpr_write_b32 a215, v17
    v_perm_b32 v16, v247, v246, s62
    v_accvgpr_write_b32 a219, v16
    v_perm_b32 v17, v247, v246, s63
    v_accvgpr_write_b32 a223, v17
    s_mul_i32 s44, s5, 163840
    s_mul_i32 s45, s37, 320
    s_add_u32 s44, s44, s45
    s_add_u32 s45, s44, 81920
    buffer_load_dwordx4 v[208:211], v5, s[20:23], s45 offen
    buffer_load_dword v240, v5, s[20:23], s45 offen offset:16
    s_add_u32 s45, s44, 83200
    buffer_load_dwordx4 v[212:215], v5, s[20:23], s45 offen
    buffer_load_dword v241, v5, s[20:23], s45 offen offset:16
    s_add_u32 s45, s44, 84480
    buffer_load_dwordx4 v[216:219], v5, s[20:23], s45 offen
    buffer_load_dword v242, v5, s[20:23], s45 offen offset:16
    s_add_u32 s45, s44, 85760
    buffer_load_dwordx4 v[220:223], v5, s[20:23], s45 offen
    buffer_load_dword v243, v5, s[20:23], s45 offen offset:16
    s_add_u32 s45, s44, 87040
    buffer_load_dwordx4 v[224:227], v5, s[20:23], s45 offen
    buffer_load_dword v244, v5, s[20:23], s45 offen offset:16
    s_add_u32 s45, s44, 88320
    buffer_load_dwordx4 v[228:231], v5, s[20:23], s45 offen
    buffer_load_dword v245, v5, s[20:23], s45 offen offset:16
    s_add_u32 s45, s44, 89600
    buffer_load_dwordx4 v[232:235], v5, s[20:23], s45 offen
    buffer_load_dword v246, v5, s[20:23], s45 offen offset:16
    s_add_u32 s45, s44, 90880
    buffer_load_dwordx4 v[236:239], v5, s[20:23], s45 offen
    buffer_load_dword v247, v5, s[20:23], s45 offen offset:16
    s_waitcnt vmcnt(0)
    v_perm_b32 v16, v212, v208, s62
    v_accvgpr_write_b32 a224, v16
    v_perm_b32 v17, v212, v208, s63
    v_accvgpr_write_b32 a228, v17
    v_perm_b32 v16, v213, v209, s62
    v_accvgpr_write_b32 a232, v16
    v_perm_b32 v17, v213, v209, s63
    v_accvgpr_write_b32 a236, v17
    v_perm_b32 v16, v214, v210, s62
    v_accvgpr_write_b32 a240, v16
    v_perm_b32 v17, v214, v210, s63
    v_accvgpr_write_b32 a244, v17
    v_perm_b32 v16, v215, v211, s62
    v_accvgpr_write_b32 a248, v16
    v_perm_b32 v17, v215, v211, s63
    v_accvgpr_write_b32 a252, v17
    v_perm_b32 v248, v241, v240, s62
    v_perm_b32 v252, v241, v240, s63
    v_perm_b32 v16, v220, v216, s62
    v_accvgpr_write_b32 a225, v16
    v_perm_b32 v17, v220, v216, s63
    v_accvgpr_write_b32 a229, v17
    v_perm_b32 v16, v221, v217, s62
    v_accvgpr_write_b32 a233, v16
    v_perm_b32 v17, v221, v217, s63
    v_accvgpr_write_b32 a237, v17
    v_perm_b32 v16, v222, v218, s62
    v_accvgpr_write_b32 a241, v16
    v_perm_b32 v17, v222, v218, s63
    v_accvgpr_write_b32 a245, v17
    v_perm_b32 v16, v223, v219, s62
    v_accvgpr_write_b32 a249, v16
    v_perm_b32 v17, v223, v219, s63
    v_accvgpr_write_b32 a253, v17
    v_perm_b32 v249, v243, v242, s62
    v_perm_b32 v253, v243, v242, s63
    v_perm_b32 v16, v228, v224, s62
    v_accvgpr_write_b32 a226, v16
    v_perm_b32 v17, v228, v224, s63
    v_accvgpr_write_b32 a230, v17
    v_perm_b32 v16, v229, v225, s62
    v_accvgpr_write_b32 a234, v16
    v_perm_b32 v17, v229, v225, s63
    v_accvgpr_write_b32 a238, v17
    v_perm_b32 v16, v230, v226, s62
    v_accvgpr_write_b32 a242, v16
    v_perm_b32 v17, v230, v226, s63
    v_accvgpr_write_b32 a246, v17
    v_perm_b32 v16, v231, v227, s62
    v_accvgpr_write_b32 a250, v16
    v_perm_b32 v17, v231, v227, s63
    v_accvgpr_write_b32 a254, v17
    v_perm_b32 v250, v245, v244, s62
    v_perm_b32 v254, v245, v244, s63
    v_perm_b32 v16, v236, v232, s62
    v_accvgpr_write_b32 a227, v16
    v_perm_b32 v17, v236, v232, s63
    v_accvgpr_write_b32 a231, v17
    v_perm_b32 v16, v237, v233, s62
    v_accvgpr_write_b32 a235, v16
    v_perm_b32 v17, v237, v233, s63
    v_accvgpr_write_b32 a239, v17
    v_perm_b32 v16, v238, v234, s62
    v_accvgpr_write_b32 a243, v16
    v_perm_b32 v17, v238, v234, s63
    v_accvgpr_write_b32 a247, v17
    v_perm_b32 v16, v239, v235, s62
    v_accvgpr_write_b32 a251, v16
    v_perm_b32 v17, v239, v235, s63
    v_accvgpr_write_b32 a255, v17
    v_perm_b32 v251, v247, v246, s62
    v_perm_b32 v255, v247, v246, s63
    s_mul_i32 s44, s5, 163840
    s_mul_i32 s45, s37, 320
    s_add_u32 s44, s44, s45
    s_add_u32 s45, s44, 122880
    buffer_load_dwordx4 v[20:23], v5, s[20:23], s45 offen
    buffer_load_dword v36, v5, s[20:23], s45 offen offset:16
    s_add_u32 s45, s44, 124160
    buffer_load_dwordx4 v[24:27], v5, s[20:23], s45 offen
    buffer_load_dword v37, v5, s[20:23], s45 offen offset:16
    s_add_u32 s45, s44, 125440
    buffer_load_dwordx4 v[28:31], v5, s[20:23], s45 offen
    buffer_load_dword v38, v5, s[20:23], s45 offen offset:16
    s_add_u32 s45, s44, 126720
    buffer_load_dwordx4 v[32:35], v5, s[20:23], s45 offen
    buffer_load_dword v39, v5, s[20:23], s45 offen offset:16
    s_waitcnt vmcnt(0)
    v_perm_b32 v208, v24, v20, s62
    v_perm_b32 v212, v24, v20, s63
    v_perm_b32 v216, v25, v21, s62
    v_perm_b32 v220, v25, v21, s63
    v_perm_b32 v224, v26, v22, s62
    v_perm_b32 v228, v26, v22, s63
    v_perm_b32 v232, v27, v23, s62
    v_perm_b32 v236, v27, v23, s63
    v_perm_b32 v240, v37, v36, s62
    v_perm_b32 v244, v37, v36, s63
    v_perm_b32 v209, v32, v28, s62
    v_perm_b32 v213, v32, v28, s63
    v_perm_b32 v217, v33, v29, s62
    v_perm_b32 v221, v33, v29, s63
    v_perm_b32 v225, v34, v30, s62
    v_perm_b32 v229, v34, v30, s63
    v_perm_b32 v233, v35, v31, s62
    v_perm_b32 v237, v35, v31, s63
    v_perm_b32 v241, v39, v38, s62
    v_perm_b32 v245, v39, v38, s63
    s_mul_i32 s44, s5, 163840
    s_mul_i32 s45, s37, 320
    s_add_u32 s44, s44, s45
    s_add_u32 s45, s44, 128000
    buffer_load_dwordx4 v[20:23], v5, s[20:23], s45 offen
    buffer_load_dword v36, v5, s[20:23], s45 offen offset:16
    s_add_u32 s45, s44, 129280
    buffer_load_dwordx4 v[24:27], v5, s[20:23], s45 offen
    buffer_load_dword v37, v5, s[20:23], s45 offen offset:16
    s_add_u32 s45, s44, 130560
    buffer_load_dwordx4 v[28:31], v5, s[20:23], s45 offen
    buffer_load_dword v38, v5, s[20:23], s45 offen offset:16
    s_add_u32 s45, s44, 131840
    buffer_load_dwordx4 v[32:35], v5, s[20:23], s45 offen
    buffer_load_dword v39, v5, s[20:23], s45 offen offset:16
    s_waitcnt vmcnt(0)
    v_perm_b32 v210, v24, v20, s62
    v_perm_b32 v214, v24, v20, s63
    v_perm_b32 v218, v25, v21, s62
    v_perm_b32 v222, v25, v21, s63
    v_perm_b32 v226, v26, v22, s62
    v_perm_b32 v230, v26, v22, s63
    v_perm_b32 v234, v27, v23, s62
    v_perm_b32 v238, v27, v23, s63
    v_perm_b32 v242, v37, v36, s62
    v_perm_b32 v246, v37, v36, s63
    v_perm_b32 v211, v32, v28, s62
    v_perm_b32 v215, v32, v28, s63
    v_perm_b32 v219, v33, v29, s62
    v_perm_b32 v223, v33, v29, s63
    v_perm_b32 v227, v34, v30, s62
    v_perm_b32 v231, v34, v30, s63
    v_perm_b32 v235, v35, v31, s62
    v_perm_b32 v239, v35, v31, s63
    v_perm_b32 v243, v39, v38, s62
    v_perm_b32 v247, v39, v38, s63
    s_nop 0
    s_branch L_c2
L_cloop:
    v_mov_b32 v6, v0
    v_mov_b32 v7, v1
    s_cmp_eq_u32 s7, 4
    s_cbranch_scc1 L_c4
    s_lshl_b32 s44, s7, 9
    v_add_u32 v16, s44, v3
    ds_read_b64 v[0:1], v16
    s_lshl_b32 s49, s7, 2
    s_call_b64 s[78:79], S_B
    v_mov_b32 v40, v0
    v_mov_b32 v41, v1
    s_mov_b32 s47, -1
    s_call_b64 s[78:79], S_C
    s_add_u32 s49, s49, 1
    s_call_b64 s[78:79], S_D
    v_mov_b32 v0, v40
    v_mov_b32 v1, v41
    v_lshrrev_b32 v17, 8, v2
    v_mul_u32_u24 v16, 10, v17
    v_bfe_u32 v17, v2, 7, 1
    v_lshl_add_u32 v16, v17, 0, v16
    v_and_b32 v17, 0x70, v2
    v_lshl_add_u32 v16, v16, 13, v17
    s_add_u32 s39, s40, 65536
    buffer_load_dwordx4 a[112:115], v16, s[8:11], s39 offen
    s_add_u32 s39, s40, 65664
    buffer_load_dwordx4 a[116:119], v16, s[8:11], s39 offen
    s_add_u32 s39, s40, 393216
    buffer_load_dwordx4 a[120:123], v16, s[8:11], s39 offen
    s_add_u32 s39, s40, 393344
    buffer_load_dwordx4 a[124:127], v16, s[8:11], s39 offen
    s_add_u32 s39, s40, 720896
    buffer_load_dwordx4 a[128:131], v16, s[8:11], s39 offen
    s_add_u32 s39, s40, 721024
    buffer_load_dwordx4 a[132:135], v16, s[8:11], s39 offen
    s_add_u32 s39, s40, 1048576
    buffer_load_dwordx4 a[136:139], v16, s[8:11], s39 offen
    s_add_u32 s39, s40, 1048704
    buffer_load_dwordx4 a[140:143], v16, s[8:11], s39 offen
L_c4:
    s_lshl_b32 s49, s7, 2
    s_sub_u32 s49, s49, 1
    s_call_b64 s[78:79], S_B
    s_lshl_b32 s44, s3, 3
    s_add_u32 s44, s44, s36
    s_cmp_lg_u32 s44, s7
    s_cbranch_scc1 Lc4_138
    s_lshl_b32 s49, s7, 2
    s_sub_u32 s49, s49, 1
    v_mov_b32 v40, v6
    v_mov_b32 v41, v7
    s_mov_b32 s47, -1
    s_call_b64 s[78:79], S_C
    v_bfe_u32 v18, v2, 4, 2
    v_mul_u32_u24 v16, 40, v18
    v_bfe_u32 v18, v2, 6, 1
    v_add3_u32 v17, v16, v18, 8
    v_bfe_u32 v18, v2, 6, 2
    v_add_u32 v16, v16, v18
    v_lshrrev_b32 v18, 8, v2
    v_mad_u32_u24 v17, v18, 10, v17
    v_lshrrev_b32 v18, 9, v2
    v_mad_u32_u24 v16, v18, 20, v16
    v_bfe_u32 v18, v2, 8, 1
    v_lshl_add_u32 v16, v18, 2, v16
    v_lshlrev_b32 v16, 1, v16
    v_lshlrev_b32 v17, 1, v17
    s_sub_u32 s44, s7, 1
    s_mul_i32 s44, s44, 1280
    s_mul_i32 s45, s37, 320
    s_add_u32 s44, s44, s45
    buffer_store_short v40, v16, s[32:35], s44 offen
    buffer_store_short_d16_hi v40, v16, s[32:35], s44 offen offset:20
    buffer_store_short v41, v17, s[32:35], s44 offen
Lc4_138:
    s_cmp_eq_u32 s7, 4
    s_cbranch_scc1 L_cend
L_c2:
    s_lshl_b32 s49, s7, 2
    s_add_u32 s49, s49, 1
    s_call_b64 s[78:79], S_B
    v_mov_b32 v40, v0
    v_mov_b32 v41, v1
    s_mov_b32 s47, -1
    s_call_b64 s[78:79], S_C
    s_add_u32 s49, s49, 1
    s_call_b64 s[78:79], S_D
    v_mov_b32 v0, v40
    v_mov_b32 v1, v41
    v_lshrrev_b32 v17, 8, v2
    v_mul_u32_u24 v16, 10, v17
    v_bfe_u32 v17, v2, 7, 1
    v_lshl_add_u32 v16, v17, 0, v16
    v_and_b32 v17, 0x70, v2
    v_lshl_add_u32 v16, v16, 13, v17
    s_add_u32 s39, s40, 65536
    buffer_load_dwordx4 a[112:115], v16, s[12:15], s39 offen
    s_add_u32 s39, s40, 65664
    buffer_load_dwordx4 a[116:119], v16, s[12:15], s39 offen
    s_add_u32 s39, s40, 393216
    buffer_load_dwordx4 a[120:123], v16, s[12:15], s39 offen
    s_add_u32 s39, s40, 393344
    buffer_load_dwordx4 a[124:127], v16, s[12:15], s39 offen
    s_add_u32 s39, s40, 720896
    buffer_load_dwordx4 a[128:131], v16, s[12:15], s39 offen
    s_add_u32 s39, s40, 721024
    buffer_load_dwordx4 a[132:135], v16, s[12:15], s39 offen
    s_add_u32 s39, s40, 1048576
    buffer_load_dwordx4 a[136:139], v16, s[12:15], s39 offen
    s_add_u32 s39, s40, 1048704
    buffer_load_dwordx4 a[140:143], v16, s[12:15], s39 offen
    s_lshl_b32 s49, s7, 2
    s_add_u32 s49, s49, 2
    s_call_b64 s[78:79], S_B
    v_mov_b32 v40, v0
    v_mov_b32 v41, v1
    s_mov_b32 s47, -1
    s_call_b64 s[78:79], S_C
    s_add_u32 s49, s49, 1
    s_call_b64 s[78:79], S_D
    v_mov_b32 v0, v40
    v_mov_b32 v1, v41
    s_add_u32 s7, s7, 1
    s_branch L_cloop
L_cend:
    s_endpgm
S_B:
    s_lshl_b32 s45, s49, 17
    s_lshl_b32 s46, s5, 12
    s_add_u32 s45, s45, s46
    s_lshr_b32 s46, s45, 6
    s_add_u32 s46, s46, 2097152
    v_and_b32 v16, 0x30, v2
    v_lshrrev_b32 v19, 3, v2
    v_lshrrev_b32 v17, 6, v2
    v_xor_b32 v19, v19, v17
    v_and_b32 v19, 8, v19
    v_or_b32 v16, v16, v19
    v_cmp_ne_u32 s[80:81], 56, v16
    v_min_u32 v16, 48, v16
    s_lshl_b32 s44, s3, 8
    s_add_u32 s44, s44, 152576
    v_lshrrev_b32 v17, 1, v2
    v_and_b32 v17, 0xf8, v17
    v_lshrrev_b32 v19, 7, v2
    v_and_b32 v19, 4, v19
    v_add3_u32 v17, v17, v19, s44
    v_lshrrev_b32 v18, 4, v2
    v_and_b32 v18, 0x30, v18
    v_add_u32 v18, s44, v18
    v_mov_b32 v32, 0
    v_mov_b32 v33, 0
    v_mov_b32 v34, 0
    v_mov_b32 v35, 0
    s_mov_b32 s42, 0
S_B_lp:
    buffer_load_dwordx4 v[20:23], v2, s[24:27], s45 offen offset:0 sc1
    buffer_load_dwordx4 v[24:27], v2, s[24:27], s45 offen offset:1024 sc1
    buffer_load_dwordx4 v[28:31], v2, s[24:27], s45 offen offset:2048 sc1
    buffer_load_dwordx2 v[36:37], v16, s[24:27], s46 offen sc1
    s_mov_b32 exec_hi, 0
    buffer_load_dwordx4 v[32:35], v2, s[24:27], s45 offen offset:3072 sc1
    s_mov_b32 exec_hi, -1
    s_waitcnt vmcnt(0)
    v_max3_u32 v19, v20, v21, v22
    v_max3_u32 v19, v19, v23, v24
    v_max3_u32 v19, v19, v25, v26
    v_max3_u32 v19, v19, v27, v28
    v_max3_u32 v19, v19, v29, v30
    v_max3_u32 v19, v19, v31, v32
    v_max3_u32 v19, v19, v33, v34
    v_max3_u32 v19, v19, v35, v36
    v_max_u32 v19, v19, v37
    v_cmp_eq_u32 vcc, -1, v19
    s_nop 0
    s_cbranch_vccz S_B_ok
    s_add_u32 s42, s42, 1
    s_cmp_lt_u32 s42, s43
    s_cbranch_scc1 S_B_lp
    s_mov_b32 s43, 0
S_B_ok:
    v_mov_b32 v19, v36
    s_nop 1
    v_max_f32_dpp v19, v19, v19 quad_perm:[1,0,3,2] row_mask:0xf bank_mask:0xf
    s_nop 1
    v_max_f32_dpp v19, v19, v19 quad_perm:[2,3,0,1] row_mask:0xf bank_mask:0xf
    s_nop 1
    v_max_f32_dpp v19, v19, v19 row_half_mirror row_mask:0xf bank_mask:0xf
    v_sub_f32 v36, v36, v19
    v_exp_f32 v36, v36
    s_nop 0
    v_cndmask_b32 v36, 0, v36, s[80:81]
    v_mul_f32 v19, v36, v37
    s_nop 0
    v_mul_f32_dpp v40, v36, v20 row_newbcast:0 row_mask:0xf bank_mask:0xf
    v_mul_f32_dpp v41, v36, v21 row_newbcast:0 row_mask:0xf bank_mask:0xf
    v_mul_f32_dpp v42, v36, v22 row_newbcast:0 row_mask:0xf bank_mask:0xf
    v_mul_f32_dpp v43, v36, v23 row_newbcast:0 row_mask:0xf bank_mask:0xf
    v_add_f32_dpp v19, v19, v19 quad_perm:[1,0,3,2] row_mask:0xf bank_mask:0xf
    v_fmac_f32_dpp v40, v36, v24 row_newbcast:1 row_mask:0xf bank_mask:0xf
    v_fmac_f32_dpp v41, v36, v25 row_newbcast:1 row_mask:0xf bank_mask:0xf
    v_fmac_f32_dpp v42, v36, v26 row_newbcast:1 row_mask:0xf bank_mask:0xf
    v_fmac_f32_dpp v43, v36, v27 row_newbcast:1 row_mask:0xf bank_mask:0xf
    v_add_f32_dpp v19, v19, v19 quad_perm:[2,3,0,1] row_mask:0xf bank_mask:0xf
    v_fmac_f32_dpp v40, v36, v28 row_newbcast:2 row_mask:0xf bank_mask:0xf
    v_fmac_f32_dpp v41, v36, v29 row_newbcast:2 row_mask:0xf bank_mask:0xf
    v_fmac_f32_dpp v42, v36, v30 row_newbcast:2 row_mask:0xf bank_mask:0xf
    v_fmac_f32_dpp v43, v36, v31 row_newbcast:2 row_mask:0xf bank_mask:0xf
    v_add_f32_dpp v19, v19, v19 row_half_mirror row_mask:0xf bank_mask:0xf
    v_fmac_f32_dpp v40, v36, v32 row_newbcast:3 row_mask:0xf bank_mask:0xf
    v_fmac_f32_dpp v41, v36, v33 row_newbcast:3 row_mask:0xf bank_mask:0xf
    v_fmac_f32_dpp v42, v36, v34 row_newbcast:3 row_mask:0xf bank_mask:0xf
    v_fmac_f32_dpp v43, v36, v35 row_newbcast:3 row_mask:0xf bank_mask:0xf
    v_rcp_f32 v19, v19
    v_permlane32_swap_b32 v40, v42
    v_permlane32_swap_b32 v41, v43
    v_add_f32 v40, v40, v42
    v_add_f32 v41, v41, v43
    v_mul_f32 v40, v40, v19
    v_mul_f32 v41, v41, v19
    v_cvt_pk_bf16_f32 v40, v40, v41
    ds_write_b32 v17, v40
    ds_read_b128 v[20:23], v18 offset:0
    ds_read_b128 v[24:27], v18 offset:64
    ds_read_b128 v[28:31], v18 offset:128
    ds_read_b128 v[32:35], v18 offset:192
    s_mul_i32 s44, s38, 2560
    s_add_u32 s44, s44, 147456
    s_mul_i32 s45, s3, 384
    s_add_u32 s45, s45, s44
    s_sub_u32 s45, s45, 152576
    v_add_u32 v17, s45, v18
    v_add_u32 v16, s44, v2
    s_bitcmp1_b32 s49, 0
    s_cbranch_scc1 S_B_tB
    s_waitcnt lgkmcnt(3)
    v_mfma_f32_16x16x32_bf16 v[36:39], v[48:51], v[20:23], 0
    s_waitcnt lgkmcnt(2)
    v_mfma_f32_16x16x32_bf16 v[36:39], v[52:55], v[24:27], v[36:39]
    s_waitcnt lgkmcnt(1)
    v_mfma_f32_16x16x32_bf16 v[36:39], v[56:59], v[28:31], v[36:39]
    s_waitcnt lgkmcnt(0)
    v_mfma_f32_16x16x32_bf16 v[36:39], v[60:63], v[32:35], v[36:39]
    v_mfma_f32_16x16x32_bf16 v[40:43], v[64:67], v[20:23], 0
    v_mfma_f32_16x16x32_bf16 v[40:43], v[68:71], v[24:27], v[40:43]
    v_mfma_f32_16x16x32_bf16 v[40:43], v[72:75], v[28:31], v[40:43]
    v_mfma_f32_16x16x32_bf16 v[40:43], v[76:79], v[32:35], v[40:43]
    v_mfma_f32_16x16x32_bf16 v[44:47], v[80:83], v[20:23], 0
    v_mfma_f32_16x16x32_bf16 v[44:47], v[84:87], v[24:27], v[44:47]
    s_mov_b64 exec, s[64:65]
    s_nop 0
    ds_write_b128 v17, v[36:39] offset:0
    s_mov_b64 exec, -1
    v_mfma_f32_16x16x32_bf16 v[44:47], v[88:91], v[28:31], v[44:47]
    v_mfma_f32_16x16x32_bf16 v[44:47], v[92:95], v[32:35], v[44:47]
    v_mfma_f32_16x16x32_bf16 v[36:39], v[96:99], v[20:23], 0
    v_mfma_f32_16x16x32_bf16 v[36:39], v[100:103], v[24:27], v[36:39]
    s_mov_b64 exec, s[64:65]
    ds_write_b128 v17, v[40:43] offset:64
    s_mov_b64 exec, -1
    v_mfma_f32_16x16x32_bf16 v[36:39], v[104:107], v[28:31], v[36:39]
    v_mfma_f32_16x16x32_bf16 v[36:39], v[108:111], v[32:35], v[36:39]
    v_mfma_f32_16x16x32_bf16 v[40:43], v[112:115], v[20:23], 0
    v_mfma_f32_16x16x32_bf16 v[40:43], v[116:119], v[24:27], v[40:43]
    s_mov_b64 exec, s[64:65]
    ds_write_b128 v17, v[44:47] offset:128
    s_mov_b64 exec, -1
    v_mfma_f32_16x16x32_bf16 v[40:43], v[120:123], v[28:31], v[40:43]
    v_mfma_f32_16x16x32_bf16 v[40:43], v[124:127], v[32:35], v[40:43]
    v_mfma_f32_16x16x32_bf16 v[44:47], v[128:131], v[20:23], 0
    v_mfma_f32_16x16x32_bf16 v[44:47], v[132:135], v[24:27], v[44:47]
    s_mov_b64 exec, s[64:65]
    ds_write_b128 v17, v[36:39] offset:192
    s_mov_b64 exec, -1
    v_mfma_f32_16x16x32_bf16 v[44:47], v[136:139], v[28:31], v[44:47]
    v_mfma_f32_16x16x32_bf16 v[44:47], v[140:143], v[32:35], v[44:47]
    v_mfma_f32_16x16x32_bf16 v[36:39], v[144:147], v[20:23], 0
    v_mfma_f32_16x16x32_bf16 v[36:39], v[148:151], v[24:27], v[36:39]
    s_mov_b64 exec, s[64:65]
    ds_write_b128 v17, v[40:43] offset:256
    s_mov_b64 exec, -1
    v_mfma_f32_16x16x32_bf16 v[36:39], v[152:155], v[28:31], v[36:39]
    v_mfma_f32_16x16x32_bf16 v[36:39], v[156:159], v[32:35], v[36:39]
    v_mfma_f32_16x16x32_bf16 v[40:43], v[160:163], v[20:23], 0
    v_mfma_f32_16x16x32_bf16 v[40:43], v[164:167], v[24:27], v[40:43]
    s_mov_b64 exec, s[64:65]
    ds_write_b128 v17, v[44:47] offset:320
    s_mov_b64 exec, -1
    v_mfma_f32_16x16x32_bf16 v[40:43], v[168:171], v[28:31], v[40:43]
    v_mfma_f32_16x16x32_bf16 v[40:43], v[172:175], v[32:35], v[40:43]
    v_mfma_f32_16x16x32_bf16 v[44:47], v[176:179], v[20:23], 0
    v_mfma_f32_16x16x32_bf16 v[44:47], v[180:183], v[24:27], v[44:47]
    s_mov_b64 exec, s[64:65]
    ds_write_b128 v17, v[36:39] offset:384
    s_mov_b64 exec, -1
    v_mfma_f32_16x16x32_bf16 v[44:47], v[184:187], v[28:31], v[44:47]
    v_mfma_f32_16x16x32_bf16 v[44:47], v[188:191], v[32:35], v[44:47]
    v_mfma_f32_16x16x32_bf16 v[36:39], v[192:195], v[20:23], 0
    v_mfma_f32_16x16x32_bf16 v[36:39], v[196:199], v[24:27], v[36:39]
    s_mov_b64 exec, s[64:65]
    ds_write_b128 v17, v[40:43] offset:448
    s_mov_b64 exec, -1
    v_mfma_f32_16x16x32_bf16 v[36:39], v[200:203], v[28:31], v[36:39]
    v_mfma_f32_16x16x32_bf16 v[36:39], v[204:207], v[32:35], v[36:39]
    s_mov_b64 exec, s[64:65]
    ds_write_b128 v17, v[44:47] offset:512
    s_mov_b64 exec, -1
    s_mov_b64 exec, s[64:65]
    s_nop 3
    ds_write_b128 v17, v[36:39] offset:576
    s_mov_b64 exec, -1
    s_branch S_B_st
S_B_tB:
    s_waitcnt lgkmcnt(3)
    v_mfma_f32_16x16x32_bf16 v[36:39], a[144:147], v[20:23], 0
    s_waitcnt lgkmcnt(2)
    v_mfma_f32_16x16x32_bf16 v[36:39], a[184:187], v[24:27], v[36:39]
    s_waitcnt lgkmcnt(1)
    v_mfma_f32_16x16x32_bf16 v[36:39], a[224:227], v[28:31], v[36:39]
    s_waitcnt lgkmcnt(0)
    v_mfma_f32_16x16x32_bf16 v[36:39], v[208:211], v[32:35], v[36:39]
    v_mfma_f32_16x16x32_bf16 v[40:43], a[148:151], v[20:23], 0
    v_mfma_f32_16x16x32_bf16 v[40:43], a[188:191], v[24:27], v[40:43]
    v_mfma_f32_16x16x32_bf16 v[40:43], a[228:231], v[28:31], v[40:43]
    v_mfma_f32_16x16x32_bf16 v[40:43], v[212:215], v[32:35], v[40:43]
    v_mfma_f32_16x16x32_bf16 v[44:47], a[152:155], v[20:23], 0
    v_mfma_f32_16x16x32_bf16 v[44:47], a[192:195], v[24:27], v[44:47]
    s_mov_b64 exec, s[64:65]
    s_nop 0
    ds_write_b128 v17, v[36:39] offset:0
    s_mov_b64 exec, -1
    v_mfma_f32_16x16x32_bf16 v[44:47], a[232:235], v[28:31], v[44:47]
    v_mfma_f32_16x16x32_bf16 v[44:47], v[216:219], v[32:35], v[44:47]
    v_mfma_f32_16x16x32_bf16 v[36:39], a[156:159], v[20:23], 0
    v_mfma_f32_16x16x32_bf16 v[36:39], a[196:199], v[24:27], v[36:39]
    s_mov_b64 exec, s[64:65]
    ds_write_b128 v17, v[40:43] offset:64
    s_mov_b64 exec, -1
    v_mfma_f32_16x16x32_bf16 v[36:39], a[236:239], v[28:31], v[36:39]
    v_mfma_f32_16x16x32_bf16 v[36:39], v[220:223], v[32:35], v[36:39]
    v_mfma_f32_16x16x32_bf16 v[40:43], a[160:163], v[20:23], 0
    v_mfma_f32_16x16x32_bf16 v[40:43], a[200:203], v[24:27], v[40:43]
    s_mov_b64 exec, s[64:65]
    ds_write_b128 v17, v[44:47] offset:128
    s_mov_b64 exec, -1
    v_mfma_f32_16x16x32_bf16 v[40:43], a[240:243], v[28:31], v[40:43]
    v_mfma_f32_16x16x32_bf16 v[40:43], v[224:227], v[32:35], v[40:43]
    v_mfma_f32_16x16x32_bf16 v[44:47], a[164:167], v[20:23], 0
    v_mfma_f32_16x16x32_bf16 v[44:47], a[204:207], v[24:27], v[44:47]
    s_mov_b64 exec, s[64:65]
    ds_write_b128 v17, v[36:39] offset:192
    s_mov_b64 exec, -1
    v_mfma_f32_16x16x32_bf16 v[44:47], a[244:247], v[28:31], v[44:47]
    v_mfma_f32_16x16x32_bf16 v[44:47], v[228:231], v[32:35], v[44:47]
    v_mfma_f32_16x16x32_bf16 v[36:39], a[168:171], v[20:23], 0
    v_mfma_f32_16x16x32_bf16 v[36:39], a[208:211], v[24:27], v[36:39]
    s_mov_b64 exec, s[64:65]
    ds_write_b128 v17, v[40:43] offset:256
    s_mov_b64 exec, -1
    v_mfma_f32_16x16x32_bf16 v[36:39], a[248:251], v[28:31], v[36:39]
    v_mfma_f32_16x16x32_bf16 v[36:39], v[232:235], v[32:35], v[36:39]
    v_mfma_f32_16x16x32_bf16 v[40:43], a[172:175], v[20:23], 0
    v_mfma_f32_16x16x32_bf16 v[40:43], a[212:215], v[24:27], v[40:43]
    s_mov_b64 exec, s[64:65]
    ds_write_b128 v17, v[44:47] offset:320
    s_mov_b64 exec, -1
    v_mfma_f32_16x16x32_bf16 v[40:43], a[252:255], v[28:31], v[40:43]
    v_mfma_f32_16x16x32_bf16 v[40:43], v[236:239], v[32:35], v[40:43]
    v_mfma_f32_16x16x32_bf16 v[44:47], a[176:179], v[20:23], 0
    v_mfma_f32_16x16x32_bf16 v[44:47], a[216:219], v[24:27], v[44:47]
    s_mov_b64 exec, s[64:65]
    ds_write_b128 v17, v[36:39] offset:384
    s_mov_b64 exec, -1
    v_mfma_f32_16x16x32_bf16 v[44:47], v[248:251], v[28:31], v[44:47]
    v_mfma_f32_16x16x32_bf16 v[44:47], v[240:243], v[32:35], v[44:47]
    v_mfma_f32_16x16x32_bf16 v[36:39], a[180:183], v[20:23], 0
    v_mfma_f32_16x16x32_bf16 v[36:39], a[220:223], v[24:27], v[36:39]
    s_mov_b64 exec, s[64:65]
    ds_write_b128 v17, v[40:43] offset:448
    s_mov_b64 exec, -1
    v_mfma_f32_16x16x32_bf16 v[36:39], v[252:255], v[28:31], v[36:39]
    v_mfma_f32_16x16x32_bf16 v[36:39], v[244:247], v[32:35], v[36:39]
    s_mov_b64 exec, s[64:65]
    ds_write_b128 v17, v[44:47] offset:512
    s_mov_b64 exec, -1
    s_mov_b64 exec, s[64:65]
    s_nop 3
    ds_write_b128 v17, v[36:39] offset:576
    s_mov_b64 exec, -1
S_B_st:
    v_mov_b32 v19, 1
    v_lshl_add_u32 v18, s38, 2, v4
    s_mov_b64 exec, 1
    ds_add_rtn_u32 v19, v18, v19 offset:8192
    s_mov_b32 exec_lo, -1
    s_mov_b32 exec_hi, 0xff
    ds_read_b128 v[20:23], v16 offset:0
    ds_read_b128 v[24:27], v16 offset:640
    ds_read_b128 v[28:31], v16 offset:1280
    ds_read_b128 v[32:35], v16 offset:1920
    s_lshl_b32 s45, s49, 2
    s_add_u32 s45, s45, s37
    s_mul_i32 s45, s45, 5120
    s_add_u32 s45, s45, 3735552
    s_lshl_b32 s44, s36, 9
    s_lshl_b32 s46, s36, 7
    s_add_u32 s46, s46, 3584
    v_add_u32 v17, s44, v2
    s_mov_b32 exec_lo, 0
    v_add_u32 v17, s46, v2
    s_mov_b64 exec, -1
    s_xor_b32 s38, s38, 1
    s_waitcnt lgkmcnt(4)
    v_readfirstlane_b32 s44, v19
    s_nop 0
    s_and_b32 s44, s44, 3
    s_cmp_eq_u32 s44, 3
    s_waitcnt lgkmcnt(0)
    s_cbranch_scc0 S_B_x
    v_pk_add_f32 v[20:21], v[20:21], v[24:25]
    v_pk_add_f32 v[22:23], v[22:23], v[26:27]
    v_pk_add_f32 v[28:29], v[28:29], v[32:33]
    v_pk_add_f32 v[30:31], v[30:31], v[34:35]
    v_pk_add_f32 v[20:21], v[20:21], v[28:29]
    v_pk_add_f32 v[22:23], v[22:23], v[30:31]
    s_mov_b32 exec_hi, 0xff
    buffer_store_dwordx4 v[20:23], v17, s[24:27], s45 offen sc1
    s_mov_b64 exec, -1
S_B_x:
    s_waitcnt vmcnt(0)
    s_barrier
    s_setpc_b64 s[78:79]
S_C:
    s_lshl_b32 s45, s49, 2
    s_add_u32 s45, s45, s37
    s_mul_i32 s45, s45, 5120
    s_add_u32 s45, s45, 3735552
    s_add_u32 s46, s45, 4096
    s_mov_b32 s42, 0
    buffer_load_dwordx4 v[20:23], v2, s[24:27], s45 offen offset:0 sc1
    buffer_load_dwordx4 v[24:27], v2, s[24:27], s45 offen offset:1024 sc1
    buffer_load_dwordx4 v[28:31], v2, s[24:27], s45 offen offset:2048 sc1
    buffer_load_dwordx4 v[32:35], v2, s[24:27], s45 offen offset:3072 sc1
    buffer_load_dwordx4 v[36:39], v2, s[24:27], s46 offen offset:0 sc1
    s_branch S_C_chk
S_C_lp:
    v_max3_u32 v16, v20, v21, v22
    v_max_u32 v16, v16, v23
    v_cmp_eq_u32 vcc, -1, v16
    s_nop 0
    s_cbranch_vccz Lcm_139
    s_mov_b64 exec, vcc
    buffer_load_dwordx4 v[20:23], v2, s[24:27], s45 offen offset:0 sc1
    s_mov_b64 exec, -1
Lcm_139:
    v_max3_u32 v16, v24, v25, v26
    v_max_u32 v16, v16, v27
    v_cmp_eq_u32 vcc, -1, v16
    s_nop 0
    s_cbranch_vccz Lcm_140
    s_mov_b64 exec, vcc
    buffer_load_dwordx4 v[24:27], v2, s[24:27], s45 offen offset:1024 sc1
    s_mov_b64 exec, -1
Lcm_140:
    v_max3_u32 v16, v28, v29, v30
    v_max_u32 v16, v16, v31
    v_cmp_eq_u32 vcc, -1, v16
    s_nop 0
    s_cbranch_vccz Lcm_141
    s_mov_b64 exec, vcc
    buffer_load_dwordx4 v[28:31], v2, s[24:27], s45 offen offset:2048 sc1
    s_mov_b64 exec, -1
Lcm_141:
    v_max3_u32 v16, v32, v33, v34
    v_max_u32 v16, v16, v35
    v_cmp_eq_u32 vcc, -1, v16
    s_nop 0
    s_cbranch_vccz Lcm_142
    s_mov_b64 exec, vcc
    buffer_load_dwordx4 v[32:35], v2, s[24:27], s45 offen offset:3072 sc1
    s_mov_b64 exec, -1
Lcm_142:
    v_max3_u32 v16, v36, v37, v38
    v_max_u32 v16, v16, v39
    v_cmp_eq_u32 vcc, -1, v16
    s_nop 0
    s_cbranch_vccz Lcm_143
    s_mov_b64 exec, vcc
    buffer_load_dwordx4 v[36:39], v2, s[24:27], s46 offen offset:0 sc1
    s_mov_b64 exec, -1
Lcm_143:
S_C_chk:
    s_waitcnt vmcnt(0)
    v_max3_u32 v16, v20, v21, v22
    v_max3_u32 v16, v16, v23, v24
    v_max3_u32 v16, v16, v25, v26
    v_max3_u32 v16, v16, v27, v28
    v_max3_u32 v16, v16, v29, v30
    v_max3_u32 v16, v16, v31, v32
    v_max3_u32 v16, v16, v33, v34
    v_max3_u32 v16, v16, v35, v36
    v_max3_u32 v16, v16, v37, v38
    v_max_u32 v16, v16, v39
    v_cmp_eq_u32 vcc, -1, v16
    s_nop 0
    s_cbranch_vccz S_C_ok
    s_add_u32 s42, s42, 1
    s_cmp_lt_u32 s42, s43
    s_cbranch_scc1 S_C_lp
    s_mov_b32 s43, 0
S_C_ok:
    v_permlane32_swap_b32 v36, v38
    v_permlane32_swap_b32 v37, v39
    v_pk_add_f32 v[20:21], v[20:21], v[24:25]
    v_pk_add_f32 v[22:23], v[22:23], v[26:27]
    v_pk_add_f32 v[28:29], v[28:29], v[32:33]
    v_pk_add_f32 v[30:31], v[30:31], v[34:35]
    v_add_f32 v36, v36, v38
    v_add_f32 v37, v37, v39
    v_pk_add_f32 v[20:21], v[20:21], v[28:29]
    v_pk_add_f32 v[22:23], v[22:23], v[30:31]
    v_permlane16_swap_b32 v36, v37
    s_nop 0
    v_permlane32_swap_b32 v20, v22
    v_permlane32_swap_b32 v21, v23
    v_add_f32 v20, v20, v22
    v_add_f32 v21, v21, v23
    v_add_f32 v36, v36, v37
    v_cvt_pk_bf16_f32 v16, v20, v21
    v_lshlrev_b32 v20, 16, v16
    v_and_b32 v21, 0xffff0000, v16
    v_add_f32_dpp v36, v36, v36 row_ror:8 row_mask:0xf bank_mask:0xf
    v_lshlrev_b32 v16, 16, v40
    v_add_f32 v20, v20, v16
    v_and_b32 v16, 0xffff0000, v40
    v_add_f32 v21, v21, v16
    v_cvt_pk_bf16_f32 v16, v36, v36
    v_lshlrev_b32 v36, 16, v16
    v_cvt_pk_bf16_f32 v40, v20, v21
    v_lshlrev_b32 v16, 16, v41
    v_add_f32 v36, v36, v16
    v_cvt_pk_bf16_f32 v41, v36, v36
    s_nop 0
    s_setpc_b64 s[78:79]
S_D:
    s_lshl_b32 s44, s49, 5
    s_add_u32 s44, s44, s5
    s_lshl_b32 s44, s44, 2
    s_add_u32 s44, s44, s37
    s_lshl_b32 s45, s44, 9
    s_add_u32 s45, s45, 2490368
    s_lshl_b32 s46, s44, 4
    s_add_u32 s46, s46, 3538944
S_D2:
    v_mov_b32 v16, v41
    v_add_u32 v18, s52, v2
    v_mov_b32_dpp v16, v41 row_shl:4 row_mask:0xf bank_mask:0x4
    s_nop 1
    v_mov_b32_dpp v17, v16 row_half_mirror row_mask:0xf bank_mask:0xf
    v_and_b32_dpp v20, v16, v8 quad_perm:[0,0,0,0] row_mask:0xf bank_mask:0xf
    v_and_b32_dpp v21, v16, v9 quad_perm:[0,0,0,0] row_mask:0xf bank_mask:0xf
    v_and_b32_dpp v22, v17, v10 quad_perm:[3,3,3,3] row_mask:0xf bank_mask:0xf
    v_and_b32_dpp v23, v17, v11 quad_perm:[3,3,3,3] row_mask:0xf bank_mask:0xf
    s_bitcmp1_b32 s49, 0
    s_cbranch_scc1 S_D_tB
    ds_read_b128 v[36:39], v18 offset:0
    ds_read_b128 v[44:47], v18 offset:1024
    ds_read_b128 v[12:15], v18 offset:2048
    v_mfma_f32_16x16x32_bf16 v[28:31], v[20:23], a[112:115], 0
    v_and_b32_dpp v24, v16, v8 quad_perm:[1,1,1,1] row_mask:0xf bank_mask:0xf
    v_and_b32_dpp v25, v16, v9 quad_perm:[1,1,1,1] row_mask:0xf bank_mask:0xf
    v_and_b32_dpp v26, v17, v10 quad_perm:[2,2,2,2] row_mask:0xf bank_mask:0xf
    v_and_b32_dpp v27, v17, v11 quad_perm:[2,2,2,2] row_mask:0xf bank_mask:0xf
    v_mfma_f32_16x16x32_bf16 v[32:35], v[20:23], a[116:119], 0
    v_lshlrev_b32 v19, 16, v41
    v_mfma_f32_16x16x32_bf16 v[28:31], v[24:27], a[120:123], v[28:31]
    v_and_b32_dpp v20, v16, v8 quad_perm:[2,2,2,2] row_mask:0xf bank_mask:0xf
    v_and_b32_dpp v21, v16, v9 quad_perm:[2,2,2,2] row_mask:0xf bank_mask:0xf
    v_and_b32_dpp v22, v17, v10 quad_perm:[1,1,1,1] row_mask:0xf bank_mask:0xf
    v_and_b32_dpp v23, v17, v11 quad_perm:[1,1,1,1] row_mask:0xf bank_mask:0xf
    v_mfma_f32_16x16x32_bf16 v[32:35], v[24:27], a[124:127], v[32:35]
    v_mul_f32 v42, 0.5, v19
    v_mul_f32 v43, v42, v19
    v_mfma_f32_16x16x32_bf16 v[28:31], v[20:23], a[128:131], v[28:31]
    v_and_b32_dpp v24, v16, v8 quad_perm:[3,3,3,3] row_mask:0xf bank_mask:0xf
    v_and_b32_dpp v25, v16, v9 quad_perm:[3,3,3,3] row_mask:0xf bank_mask:0xf
    v_and_b32_dpp v26, v17, v10 quad_perm:[0,0,0,0] row_mask:0xf bank_mask:0xf
    v_and_b32_dpp v27, v17, v11 quad_perm:[0,0,0,0] row_mask:0xf bank_mask:0xf
    v_mfma_f32_16x16x32_bf16 v[32:35], v[20:23], a[132:135], v[32:35]
    v_lshlrev_b32 v19, 16, v40
    v_mfma_f32_16x16x32_bf16 v[28:31], v[24:27], a[136:139], v[28:31]
    v_perm_b32 v16, v40, v40, s62
    s_nop 1
    v_mov_b32_dpp v17, v16 row_half_mirror row_mask:0xf bank_mask:0xf
    v_and_b32_dpp v20, v16, v8 quad_perm:[0,0,0,0] row_mask:0xf bank_mask:0xf
    v_and_b32_dpp v21, v16, v9 quad_perm:[0,0,0,0] row_mask:0xf bank_mask:0xf
    v_and_b32_dpp v22, v17, v10 quad_perm:[3,3,3,3] row_mask:0xf bank_mask:0xf
    v_and_b32_dpp v23, v17, v11 quad_perm:[3,3,3,3] row_mask:0xf bank_mask:0xf
    v_mfma_f32_16x16x32_bf16 v[32:35], v[24:27], a[140:143], v[32:35]
    v_add_f32 v42, v42, v19
    v_fmac_f32 v43, v19, v19
    s_waitcnt lgkmcnt(2)
    v_mfma_f32_16x16x32_bf16 v[28:31], v[20:23], v[36:39], v[28:31]
    ds_read_b128 v[36:39], v18 offset:3072
    v_and_b32_dpp v24, v16, v8 quad_perm:[1,1,1,1] row_mask:0xf bank_mask:0xf
    v_and_b32_dpp v25, v16, v9 quad_perm:[1,1,1,1] row_mask:0xf bank_mask:0xf
    v_and_b32_dpp v26, v17, v10 quad_perm:[2,2,2,2] row_mask:0xf bank_mask:0xf
    v_and_b32_dpp v27, v17, v11 quad_perm:[2,2,2,2] row_mask:0xf bank_mask:0xf
    s_waitcnt lgkmcnt(2)
    v_mfma_f32_16x16x32_bf16 v[32:35], v[20:23], v[44:47], v[32:35]
    ds_read_b128 v[44:47], v18 offset:4096
    v_and_b32 v19, 0xffff0000, v40
    s_waitcnt lgkmcnt(2)
    v_mfma_f32_16x16x32_bf16 v[28:31], v[24:27], v[12:15], v[28:31]
    ds_read_b128 v[12:15], v18 offset:5120
    v_and_b32_dpp v20, v16, v8 quad_perm:[2,2,2,2] row_mask:0xf bank_mask:0xf
    v_and_b32_dpp v21, v16, v9 quad_perm:[2,2,2,2] row_mask:0xf bank_mask:0xf
    v_and_b32_dpp v22, v17, v10 quad_perm:[1,1,1,1] row_mask:0xf bank_mask:0xf
    v_and_b32_dpp v23, v17, v11 quad_perm:[1,1,1,1] row_mask:0xf bank_mask:0xf
    s_waitcnt lgkmcnt(2)
    v_mfma_f32_16x16x32_bf16 v[32:35], v[24:27], v[36:39], v[32:35]
    ds_read_b128 v[36:39], v18 offset:6144
    v_add_f32 v42, v42, v19
    v_fmac_f32 v43, v19, v19
    v_mfma_f32_16x16x32_bf16 v[28:31], v[20:23], a[0:3], v[28:31]
    v_and_b32_dpp v24, v16, v8 quad_perm:[3,3,3,3] row_mask:0xf bank_mask:0xf
    v_and_b32_dpp v25, v16, v9 quad_perm:[3,3,3,3] row_mask:0xf bank_mask:0xf
    v_and_b32_dpp v26, v17, v10 quad_perm:[0,0,0,0] row_mask:0xf bank_mask:0xf
    v_and_b32_dpp v27, v17, v11 quad_perm:[0,0,0,0] row_mask:0xf bank_mask:0xf
    s_waitcnt lgkmcnt(2)
    v_mfma_f32_16x16x32_bf16 v[32:35], v[20:23], v[44:47], v[32:35]
    ds_read_b128 v[44:47], v18 offset:7168
    v_add_f32_dpp v42, v42, v42 quad_perm:[1,0,3,2] row_mask:0xf bank_mask:0xf
    v_mfma_f32_16x16x32_bf16 v[28:31], v[24:27], a[4:7], v[28:31]
    v_and_b32_dpp v20, v17, v8 quad_perm:[3,3,3,3] row_mask:0xf bank_mask:0xf
    v_and_b32_dpp v21, v17, v9 quad_perm:[3,3,3,3] row_mask:0xf bank_mask:0xf
    v_and_b32_dpp v22, v16, v10 quad_perm:[0,0,0,0] row_mask:0xf bank_mask:0xf
    v_and_b32_dpp v23, v16, v11 quad_perm:[0,0,0,0] row_mask:0xf bank_mask:0xf
    s_waitcnt lgkmcnt(2)
    v_mfma_f32_16x16x32_bf16 v[32:35], v[24:27], v[12:15], v[32:35]
    ds_read_b128 v[12:15], v18 offset:8192
    v_add_f32_dpp v43, v43, v43 quad_perm:[1,0,3,2] row_mask:0xf bank_mask:0xf
    v_mfma_f32_16x16x32_bf16 v[28:31], v[20:23], a[8:11], v[28:31]
    v_and_b32_dpp v24, v17, v8 quad_perm:[2,2,2,2] row_mask:0xf bank_mask:0xf
    v_and_b32_dpp v25, v17, v9 quad_perm:[2,2,2,2] row_mask:0xf bank_mask:0xf
    v_and_b32_dpp v26, v16, v10 quad_perm:[1,1,1,1] row_mask:0xf bank_mask:0xf
    v_and_b32_dpp v27, v16, v11 quad_perm:[1,1,1,1] row_mask:0xf bank_mask:0xf
    s_waitcnt lgkmcnt(2)
    v_mfma_f32_16x16x32_bf16 v[32:35], v[20:23], v[36:39], v[32:35]
    ds_read_b128 v[36:39], v18 offset:9216
    v_add_f32_dpp v42, v42, v42 quad_perm:[2,3,0,1] row_mask:0xf bank_mask:0xf
    v_mfma_f32_16x16x32_bf16 v[28:31], v[24:27], a[12:15], v[28:31]
    v_and_b32_dpp v20, v17, v8 quad_perm:[1,1,1,1] row_mask:0xf bank_mask:0xf
    v_and_b32_dpp v21, v17, v9 quad_perm:[1,1,1,1] row_mask:0xf bank_mask:0xf
    v_and_b32_dpp v22, v16, v10 quad_perm:[2,2,2,2] row_mask:0xf bank_mask:0xf
    v_and_b32_dpp v23, v16, v11 quad_perm:[2,2,2,2] row_mask:0xf bank_mask:0xf
    s_waitcnt lgkmcnt(2)
    v_mfma_f32_16x16x32_bf16 v[32:35], v[24:27], v[44:47], v[32:35]
    ds_read_b128 v[44:47], v18 offset:10240
    v_add_f32_dpp v43, v43, v43 quad_perm:[2,3,0,1] row_mask:0xf bank_mask:0xf
    v_mfma_f32_16x16x32_bf16 v[28:31], v[20:23], a[16:19], v[28:31]
    v_and_b32_dpp v24, v17, v8 quad_perm:[0,0,0,0] row_mask:0xf bank_mask:0xf
    v_and_b32_dpp v25, v17, v9 quad_perm:[0,0,0,0] row_mask:0xf bank_mask:0xf
    v_and_b32_dpp v26, v16, v10 quad_perm:[3,3,3,3] row_mask:0xf bank_mask:0xf
    v_and_b32_dpp v27, v16, v11 quad_perm:[3,3,3,3] row_mask:0xf bank_mask:0xf
    s_waitcnt lgkmcnt(2)
    v_mfma_f32_16x16x32_bf16 v[32:35], v[20:23], v[12:15], v[32:35]
    ds_read_b128 v[12:15], v18 offset:11264
    v_add_f32_dpp v42, v42, v42 row_half_mirror row_mask:0xf bank_mask:0xf
    v_mfma_f32_16x16x32_bf16 v[28:31], v[24:27], a[20:23], v[28:31]
    v_perm_b32 v16, v40, v40, s63
    s_nop 1
    v_mov_b32_dpp v17, v16 row_half_mirror row_mask:0xf bank_mask:0xf
    v_and_b32_dpp v20, v16, v8 quad_perm:[0,0,0,0] row_mask:0xf bank_mask:0xf
    v_and_b32_dpp v21, v16, v9 quad_perm:[0,0,0,0] row_mask:0xf bank_mask:0xf
    v_and_b32_dpp v22, v17, v10 quad_perm:[3,3,3,3] row_mask:0xf bank_mask:0xf
    v_and_b32_dpp v23, v17, v11 quad_perm:[3,3,3,3] row_mask:0xf bank_mask:0xf
    s_waitcnt lgkmcnt(2)
    v_mfma_f32_16x16x32_bf16 v[32:35], v[24:27], v[36:39], v[32:35]
    ds_read_b128 v[36:39], v18 offset:12288
    v_add_f32_dpp v43, v43, v43 row_half_mirror row_mask:0xf bank_mask:0xf
    v_mfma_f32_16x16x32_bf16 v[28:31], v[20:23], a[24:27], v[28:31]
    v_and_b32_dpp v24, v16, v8 quad_perm:[1,1,1,1] row_mask:0xf bank_mask:0xf
    v_and_b32_dpp v25, v16, v9 quad_perm:[1,1,1,1] row_mask:0xf bank_mask:0xf
    v_and_b32_dpp v26, v17, v10 quad_perm:[2,2,2,2] row_mask:0xf bank_mask:0xf
    v_and_b32_dpp v27, v17, v11 quad_perm:[2,2,2,2] row_mask:0xf bank_mask:0xf
    s_waitcnt lgkmcnt(2)
    v_mfma_f32_16x16x32_bf16 v[32:35], v[20:23], v[44:47], v[32:35]
    ds_read_b128 v[44:47], v18 offset:13312
    v_add_f32_dpp v42, v42, v42 row_mirror row_mask:0xf bank_mask:0xf
    v_mfma_f32_16x16x32_bf16 v[28:31], v[24:27], a[28:31], v[28:31]
    v_and_b32_dpp v20, v16, v8 quad_perm:[2,2,2,2] row_mask:0xf bank_mask:0xf
    v_and_b32_dpp v21, v16, v9 quad_perm:[2,2,2,2] row_mask:0xf bank_mask:0xf
    v_and_b32_dpp v22, v17, v10 quad_perm:[1,1,1,1] row_mask:0xf bank_mask:0xf
    v_and_b32_dpp v23, v17, v11 quad_perm:[1,1,1,1] row_mask:0xf bank_mask:0xf
    s_waitcnt lgkmcnt(2)
    v_mfma_f32_16x16x32_bf16 v[32:35], v[24:27], v[12:15], v[32:35]
    ds_read_b128 v[12:15], v18 offset:14336
    v_add_f32_dpp v43, v43, v43 row_mirror row_mask:0xf bank_mask:0xf
    v_mfma_f32_16x16x32_bf16 v[28:31], v[20:23], a[32:35], v[28:31]
    v_and_b32_dpp v24, v16, v8 quad_perm:[3,3,3,3] row_mask:0xf bank_mask:0xf
    v_and_b32_dpp v25, v16, v9 quad_perm:[3,3,3,3] row_mask:0xf bank_mask:0xf
    v_and_b32_dpp v26, v17, v10 quad_perm:[0,0,0,0] row_mask:0xf bank_mask:0xf
    v_and_b32_dpp v27, v17, v11 quad_perm:[0,0,0,0] row_mask:0xf bank_mask:0xf
    s_waitcnt lgkmcnt(2)
    v_mfma_f32_16x16x32_bf16 v[32:35], v[20:23], v[36:39], v[32:35]
    ds_read_b128 v[36:39], v18 offset:15360
    v_add_f32_dpp v42, v42, v42 row_bcast:15 row_mask:0xa bank_mask:0xf
    v_mfma_f32_16x16x32_bf16 v[28:31], v[24:27], a[36:39], v[28:31]
    v_and_b32_dpp v20, v17, v8 quad_perm:[3,3,3,3] row_mask:0xf bank_mask:0xf
    v_and_b32_dpp v21, v17, v9 quad_perm:[3,3,3,3] row_mask:0xf bank_mask:0xf
    v_and_b32_dpp v22, v16, v10 quad_perm:[0,0,0,0] row_mask:0xf bank_mask:0xf
    v_and_b32_dpp v23, v16, v11 quad_perm:[0,0,0,0] row_mask:0xf bank_mask:0xf
    s_waitcnt lgkmcnt(2)
    v_mfma_f32_16x16x32_bf16 v[32:35], v[24:27], v[44:47], v[32:35]
    ds_read_b128 v[44:47], v18 offset:16384
    v_add_f32_dpp v43, v43, v43 row_bcast:15 row_mask:0xa bank_mask:0xf
    v_mfma_f32_16x16x32_bf16 v[28:31], v[20:23], a[40:43], v[28:31]
    v_and_b32_dpp v24, v17, v8 quad_perm:[2,2,2,2] row_mask:0xf bank_mask:0xf
    v_and_b32_dpp v25, v17, v9 quad_perm:[2,2,2,2] row_mask:0xf bank_mask:0xf
    v_and_b32_dpp v26, v16, v10 quad_perm:[1,1,1,1] row_mask:0xf bank_mask:0xf
    v_and_b32_dpp v27, v16, v11 quad_perm:[1,1,1,1] row_mask:0xf bank_mask:0xf
    s_waitcnt lgkmcnt(2)
    v_mfma_f32_16x16x32_bf16 v[32:35], v[20:23], v[12:15], v[32:35]
    ds_read_b128 v[12:15], v18 offset:17408
    v_add_f32_dpp v42, v42, v42 row_bcast:31 row_mask:0xc bank_mask:0xf
    v_mfma_f32_16x16x32_bf16 v[28:31], v[24:27], a[44:47], v[28:31]
    v_and_b32_dpp v20, v17, v8 quad_perm:[1,1,1,1] row_mask:0xf bank_mask:0xf
    v_and_b32_dpp v21, v17, v9 quad_perm:[1,1,1,1] row_mask:0xf bank_mask:0xf
    v_and_b32_dpp v22, v16, v10 quad_perm:[2,2,2,2] row_mask:0xf bank_mask:0xf
    v_and_b32_dpp v23, v16, v11 quad_perm:[2,2,2,2] row_mask:0xf bank_mask:0xf
    s_waitcnt lgkmcnt(2)
    v_mfma_f32_16x16x32_bf16 v[32:35], v[24:27], v[36:39], v[32:35]
    v_add_f32_dpp v43, v43, v43 row_bcast:31 row_mask:0xc bank_mask:0xf
    v_mfma_f32_16x16x32_bf16 v[28:31], v[20:23], a[48:51], v[28:31]
    v_and_b32_dpp v24, v17, v8 quad_perm:[0,0,0,0] row_mask:0xf bank_mask:0xf
    v_and_b32_dpp v25, v17, v9 quad_perm:[0,0,0,0] row_mask:0xf bank_mask:0xf
    v_and_b32_dpp v26, v16, v10 quad_perm:[3,3,3,3] row_mask:0xf bank_mask:0xf
    v_and_b32_dpp v27, v16, v11 quad_perm:[3,3,3,3] row_mask:0xf bank_mask:0xf
    s_waitcnt lgkmcnt(1)
    v_mfma_f32_16x16x32_bf16 v[32:35], v[20:23], v[44:47], v[32:35]
    v_lshrrev_b32 v19, 6, v2
    v_and_b32 v19, 8, v19
    v_mfma_f32_16x16x32_bf16 v[28:31], v[24:27], a[52:55], v[28:31]
    s_waitcnt lgkmcnt(0)
    v_mfma_f32_16x16x32_bf16 v[32:35], v[24:27], v[12:15], v[32:35]
    v_and_or_b32 v19, v2, s66, v19
    s_nop 5
    s_branch S_D_st
S_D_tB:
    ds_read_b128 v[36:39], v18 offset:18432
    ds_read_b128 v[44:47], v18 offset:19456
    ds_read_b128 v[12:15], v18 offset:20480
    v_mfma_f32_16x16x32_bf16 v[28:31], v[20:23], a[112:115], 0
    v_and_b32_dpp v24, v16, v8 quad_perm:[1,1,1,1] row_mask:0xf bank_mask:0xf
    v_and_b32_dpp v25, v16, v9 quad_perm:[1,1,1,1] row_mask:0xf bank_mask:0xf
    v_and_b32_dpp v26, v17, v10 quad_perm:[2,2,2,2] row_mask:0xf bank_mask:0xf
    v_and_b32_dpp v27, v17, v11 quad_perm:[2,2,2,2] row_mask:0xf bank_mask:0xf
    v_mfma_f32_16x16x32_bf16 v[32:35], v[20:23], a[116:119], 0
    v_lshlrev_b32 v19, 16, v41
    v_mfma_f32_16x16x32_bf16 v[28:31], v[24:27], a[120:123], v[28:31]
    v_and_b32_dpp v20, v16, v8 quad_perm:[2,2,2,2] row_mask:0xf bank_mask:0xf
    v_and_b32_dpp v21, v16, v9 quad_perm:[2,2,2,2] row_mask:0xf bank_mask:0xf
    v_and_b32_dpp v22, v17, v10 quad_perm:[1,1,1,1] row_mask:0xf bank_mask:0xf
    v_and_b32_dpp v23, v17, v11 quad_perm:[1,1,1,1] row_mask:0xf bank_mask:0xf
    v_mfma_f32_16x16x32_bf16 v[32:35], v[24:27], a[124:127], v[32:35]
    v_mul_f32 v42, 0.5, v19
    v_mul_f32 v43, v42, v19
    v_mfma_f32_16x16x32_bf16 v[28:31], v[20:23], a[128:131], v[28:31]
    v_and_b32_dpp v24, v16, v8 quad_perm:[3,3,3,3] row_mask:0xf bank_mask:0xf
    v_and_b32_dpp v25, v16, v9 quad_perm:[3,3,3,3] row_mask:0xf bank_mask:0xf
    v_and_b32_dpp v26, v17, v10 quad_perm:[0,0,0,0] row_mask:0xf bank_mask:0xf
    v_and_b32_dpp v27, v17, v11 quad_perm:[0,0,0,0] row_mask:0xf bank_mask:0xf
    v_mfma_f32_16x16x32_bf16 v[32:35], v[20:23], a[132:135], v[32:35]
    v_lshlrev_b32 v19, 16, v40
    v_mfma_f32_16x16x32_bf16 v[28:31], v[24:27], a[136:139], v[28:31]
    v_perm_b32 v16, v40, v40, s62
    s_nop 1
    v_mov_b32_dpp v17, v16 row_half_mirror row_mask:0xf bank_mask:0xf
    v_and_b32_dpp v20, v16, v8 quad_perm:[0,0,0,0] row_mask:0xf bank_mask:0xf
    v_and_b32_dpp v21, v16, v9 quad_perm:[0,0,0,0] row_mask:0xf bank_mask:0xf
    v_and_b32_dpp v22, v17, v10 quad_perm:[3,3,3,3] row_mask:0xf bank_mask:0xf
    v_and_b32_dpp v23, v17, v11 quad_perm:[3,3,3,3] row_mask:0xf bank_mask:0xf
    v_mfma_f32_16x16x32_bf16 v[32:35], v[24:27], a[140:143], v[32:35]
    v_add_f32 v42, v42, v19
    v_fmac_f32 v43, v19, v19
    s_waitcnt lgkmcnt(2)
    v_mfma_f32_16x16x32_bf16 v[28:31], v[20:23], v[36:39], v[28:31]
    ds_read_b128 v[36:39], v18 offset:21504
    v_and_b32_dpp v24, v16, v8 quad_perm:[1,1,1,1] row_mask:0xf bank_mask:0xf
    v_and_b32_dpp v25, v16, v9 quad_perm:[1,1,1,1] row_mask:0xf bank_mask:0xf
    v_and_b32_dpp v26, v17, v10 quad_perm:[2,2,2,2] row_mask:0xf bank_mask:0xf
    v_and_b32_dpp v27, v17, v11 quad_perm:[2,2,2,2] row_mask:0xf bank_mask:0xf
    s_waitcnt lgkmcnt(2)
    v_mfma_f32_16x16x32_bf16 v[32:35], v[20:23], v[44:47], v[32:35]
    ds_read_b128 v[44:47], v18 offset:22528
    v_and_b32 v19, 0xffff0000, v40
    s_waitcnt lgkmcnt(2)
    v_mfma_f32_16x16x32_bf16 v[28:31], v[24:27], v[12:15], v[28:31]
    ds_read_b128 v[12:15], v18 offset:23552
    v_and_b32_dpp v20, v16, v8 quad_perm:[2,2,2,2] row_mask:0xf bank_mask:0xf
    v_and_b32_dpp v21, v16, v9 quad_perm:[2,2,2,2] row_mask:0xf bank_mask:0xf
    v_and_b32_dpp v22, v17, v10 quad_perm:[1,1,1,1] row_mask:0xf bank_mask:0xf
    v_and_b32_dpp v23, v17, v11 quad_perm:[1,1,1,1] row_mask:0xf bank_mask:0xf
    s_waitcnt lgkmcnt(2)
    v_mfma_f32_16x16x32_bf16 v[32:35], v[24:27], v[36:39], v[32:35]
    ds_read_b128 v[36:39], v18 offset:24576
    v_add_f32 v42, v42, v19
    v_fmac_f32 v43, v19, v19
    v_mfma_f32_16x16x32_bf16 v[28:31], v[20:23], a[56:59], v[28:31]
    v_and_b32_dpp v24, v16, v8 quad_perm:[3,3,3,3] row_mask:0xf bank_mask:0xf
    v_and_b32_dpp v25, v16, v9 quad_perm:[3,3,3,3] row_mask:0xf bank_mask:0xf
    v_and_b32_dpp v26, v17, v10 quad_perm:[0,0,0,0] row_mask:0xf bank_mask:0xf
    v_and_b32_dpp v27, v17, v11 quad_perm:[0,0,0,0] row_mask:0xf bank_mask:0xf
    s_waitcnt lgkmcnt(2)
    v_mfma_f32_16x16x32_bf16 v[32:35], v[20:23], v[44:47], v[32:35]
    ds_read_b128 v[44:47], v18 offset:25600
    v_add_f32_dpp v42, v42, v42 quad_perm:[1,0,3,2] row_mask:0xf bank_mask:0xf
    v_mfma_f32_16x16x32_bf16 v[28:31], v[24:27], a[60:63], v[28:31]
    v_and_b32_dpp v20, v17, v8 quad_perm:[3,3,3,3] row_mask:0xf bank_mask:0xf
    v_and_b32_dpp v21, v17, v9 quad_perm:[3,3,3,3] row_mask:0xf bank_mask:0xf
    v_and_b32_dpp v22, v16, v10 quad_perm:[0,0,0,0] row_mask:0xf bank_mask:0xf
    v_and_b32_dpp v23, v16, v11 quad_perm:[0,0,0,0] row_mask:0xf bank_mask:0xf
    s_waitcnt lgkmcnt(2)
    v_mfma_f32_16x16x32_bf16 v[32:35], v[24:27], v[12:15], v[32:35]
    ds_read_b128 v[12:15], v18 offset:26624
    v_add_f32_dpp v43, v43, v43 quad_perm:[1,0,3,2] row_mask:0xf bank_mask:0xf
    v_mfma_f32_16x16x32_bf16 v[28:31], v[20:23], a[64:67], v[28:31]
    v_and_b32_dpp v24, v17, v8 quad_perm:[2,2,2,2] row_mask:0xf bank_mask:0xf
    v_and_b32_dpp v25, v17, v9 quad_perm:[2,2,2,2] row_mask:0xf bank_mask:0xf
    v_and_b32_dpp v26, v16, v10 quad_perm:[1,1,1,1] row_mask:0xf bank_mask:0xf
    v_and_b32_dpp v27, v16, v11 quad_perm:[1,1,1,1] row_mask:0xf bank_mask:0xf
    s_waitcnt lgkmcnt(2)
    v_mfma_f32_16x16x32_bf16 v[32:35], v[20:23], v[36:39], v[32:35]
    ds_read_b128 v[36:39], v18 offset:27648
    v_add_f32_dpp v42, v42, v42 quad_perm:[2,3,0,1] row_mask:0xf bank_mask:0xf
    v_mfma_f32_16x16x32_bf16 v[28:31], v[24:27], a[68:71], v[28:31]
    v_and_b32_dpp v20, v17, v8 quad_perm:[1,1,1,1] row_mask:0xf bank_mask:0xf
    v_and_b32_dpp v21, v17, v9 quad_perm:[1,1,1,1] row_mask:0xf bank_mask:0xf
    v_and_b32_dpp v22, v16, v10 quad_perm:[2,2,2,2] row_mask:0xf bank_mask:0xf
    v_and_b32_dpp v23, v16, v11 quad_perm:[2,2,2,2] row_mask:0xf bank_mask:0xf
    s_waitcnt lgkmcnt(2)
    v_mfma_f32_16x16x32_bf16 v[32:35], v[24:27], v[44:47], v[32:35]
    ds_read_b128 v[44:47], v18 offset:28672
    v_add_f32_dpp v43, v43, v43 quad_perm:[2,3,0,1] row_mask:0xf bank_mask:0xf
    v_mfma_f32_16x16x32_bf16 v[28:31], v[20:23], a[72:75], v[28:31]
    v_and_b32_dpp v24, v17, v8 quad_perm:[0,0,0,0] row_mask:0xf bank_mask:0xf
    v_and_b32_dpp v25, v17, v9 quad_perm:[0,0,0,0] row_mask:0xf bank_mask:0xf
    v_and_b32_dpp v26, v16, v10 quad_perm:[3,3,3,3] row_mask:0xf bank_mask:0xf
    v_and_b32_dpp v27, v16, v11 quad_perm:[3,3,3,3] row_mask:0xf bank_mask:0xf
    s_waitcnt lgkmcnt(2)
    v_mfma_f32_16x16x32_bf16 v[32:35], v[20:23], v[12:15], v[32:35]
    ds_read_b128 v[12:15], v18 offset:29696
    v_add_f32_dpp v42, v42, v42 row_half_mirror row_mask:0xf bank_mask:0xf
    v_mfma_f32_16x16x32_bf16 v[28:31], v[24:27], a[76:79], v[28:31]
    v_perm_b32 v16, v40, v40, s63
    s_nop 1
    v_mov_b32_dpp v17, v16 row_half_mirror row_mask:0xf bank_mask:0xf
    v_and_b32_dpp v20, v16, v8 quad_perm:[0,0,0,0] row_mask:0xf bank_mask:0xf
    v_and_b32_dpp v21, v16, v9 quad_perm:[0,0,0,0] row_mask:0xf bank_mask:0xf
    v_and_b32_dpp v22, v17, v10 quad_perm:[3,3,3,3] row_mask:0xf bank_mask:0xf
    v_and_b32_dpp v23, v17, v11 quad_perm:[3,3,3,3] row_mask:0xf bank_mask:0xf
    s_waitcnt lgkmcnt(2)
    v_mfma_f32_16x16x32_bf16 v[32:35], v[24:27], v[36:39], v[32:35]
    ds_read_b128 v[36:39], v18 offset:30720
    v_add_f32_dpp v43, v43, v43 row_half_mirror row_mask:0xf bank_mask:0xf
    v_mfma_f32_16x16x32_bf16 v[28:31], v[20:23], a[80:83], v[28:31]
    v_and_b32_dpp v24, v16, v8 quad_perm:[1,1,1,1] row_mask:0xf bank_mask:0xf
    v_and_b32_dpp v25, v16, v9 quad_perm:[1,1,1,1] row_mask:0xf bank_mask:0xf
    v_and_b32_dpp v26, v17, v10 quad_perm:[2,2,2,2] row_mask:0xf bank_mask:0xf
    v_and_b32_dpp v27, v17, v11 quad_perm:[2,2,2,2] row_mask:0xf bank_mask:0xf
    s_waitcnt lgkmcnt(2)
    v_mfma_f32_16x16x32_bf16 v[32:35], v[20:23], v[44:47], v[32:35]
    ds_read_b128 v[44:47], v18 offset:31744
    v_add_f32_dpp v42, v42, v42 row_mirror row_mask:0xf bank_mask:0xf
    v_mfma_f32_16x16x32_bf16 v[28:31], v[24:27], a[84:87], v[28:31]
    v_and_b32_dpp v20, v16, v8 quad_perm:[2,2,2,2] row_mask:0xf bank_mask:0xf
    v_and_b32_dpp v21, v16, v9 quad_perm:[2,2,2,2] row_mask:0xf bank_mask:0xf
    v_and_b32_dpp v22, v17, v10 quad_perm:[1,1,1,1] row_mask:0xf bank_mask:0xf
    v_and_b32_dpp v23, v17, v11 quad_perm:[1,1,1,1] row_mask:0xf bank_mask:0xf
    s_waitcnt lgkmcnt(2)
    v_mfma_f32_16x16x32_bf16 v[32:35], v[24:27], v[12:15], v[32:35]
    ds_read_b128 v[12:15], v18 offset:32768
    v_add_f32_dpp v43, v43, v43 row_mirror row_mask:0xf bank_mask:0xf
    v_mfma_f32_16x16x32_bf16 v[28:31], v[20:23], a[88:91], v[28:31]
    v_and_b32_dpp v24, v16, v8 quad_perm:[3,3,3,3] row_mask:0xf bank_mask:0xf
    v_and_b32_dpp v25, v16, v9 quad_perm:[3,3,3,3] row_mask:0xf bank_mask:0xf
    v_and_b32_dpp v26, v17, v10 quad_perm:[0,0,0,0] row_mask:0xf bank_mask:0xf
    v_and_b32_dpp v27, v17, v11 quad_perm:[0,0,0,0] row_mask:0xf bank_mask:0xf
    s_waitcnt lgkmcnt(2)
    v_mfma_f32_16x16x32_bf16 v[32:35], v[20:23], v[36:39], v[32:35]
    ds_read_b128 v[36:39], v18 offset:33792
    v_add_f32_dpp v42, v42, v42 row_bcast:15 row_mask:0xa bank_mask:0xf
    v_mfma_f32_16x16x32_bf16 v[28:31], v[24:27], a[92:95], v[28:31]
    v_and_b32_dpp v20, v17, v8 quad_perm:[3,3,3,3] row_mask:0xf bank_mask:0xf
    v_and_b32_dpp v21, v17, v9 quad_perm:[3,3,3,3] row_mask:0xf bank_mask:0xf
    v_and_b32_dpp v22, v16, v10 quad_perm:[0,0,0,0] row_mask:0xf bank_mask:0xf
    v_and_b32_dpp v23, v16, v11 quad_perm:[0,0,0,0] row_mask:0xf bank_mask:0xf
    s_waitcnt lgkmcnt(2)
    v_mfma_f32_16x16x32_bf16 v[32:35], v[24:27], v[44:47], v[32:35]
    ds_read_b128 v[44:47], v18 offset:34816
    v_add_f32_dpp v43, v43, v43 row_bcast:15 row_mask:0xa bank_mask:0xf
    v_mfma_f32_16x16x32_bf16 v[28:31], v[20:23], a[96:99], v[28:31]
    v_and_b32_dpp v24, v17, v8 quad_perm:[2,2,2,2] row_mask:0xf bank_mask:0xf
    v_and_b32_dpp v25, v17, v9 quad_perm:[2,2,2,2] row_mask:0xf bank_mask:0xf
    v_and_b32_dpp v26, v16, v10 quad_perm:[1,1,1,1] row_mask:0xf bank_mask:0xf
    v_and_b32_dpp v27, v16, v11 quad_perm:[1,1,1,1] row_mask:0xf bank_mask:0xf
    s_waitcnt lgkmcnt(2)
    v_mfma_f32_16x16x32_bf16 v[32:35], v[20:23], v[12:15], v[32:35]
    ds_read_b128 v[12:15], v18 offset:35840
    v_add_f32_dpp v42, v42, v42 row_bcast:31 row_mask:0xc bank_mask:0xf
    v_mfma_f32_16x16x32_bf16 v[28:31], v[24:27], a[100:103], v[28:31]
    v_and_b32_dpp v20, v17, v8 quad_perm:[1,1,1,1] row_mask:0xf bank_mask:0xf
    v_and_b32_dpp v21, v17, v9 quad_perm:[1,1,1,1] row_mask:0xf bank_mask:0xf
    v_and_b32_dpp v22, v16, v10 quad_perm:[2,2,2,2] row_mask:0xf bank_mask:0xf
    v_and_b32_dpp v23, v16, v11 quad_perm:[2,2,2,2] row_mask:0xf bank_mask:0xf
    s_waitcnt lgkmcnt(2)
    v_mfma_f32_16x16x32_bf16 v[32:35], v[24:27], v[36:39], v[32:35]
    v_add_f32_dpp v43, v43, v43 row_bcast:31 row_mask:0xc bank_mask:0xf
    v_mfma_f32_16x16x32_bf16 v[28:31], v[20:23], a[104:107], v[28:31]
    v_and_b32_dpp v24, v17, v8 quad_perm:[0,0,0,0] row_mask:0xf bank_mask:0xf
    v_and_b32_dpp v25, v17, v9 quad_perm:[0,0,0,0] row_mask:0xf bank_mask:0xf
    v_and_b32_dpp v26, v16, v10 quad_perm:[3,3,3,3] row_mask:0xf bank_mask:0xf
    v_and_b32_dpp v27, v16, v11 quad_perm:[3,3,3,3] row_mask:0xf bank_mask:0xf
    s_waitcnt lgkmcnt(1)
    v_mfma_f32_16x16x32_bf16 v[32:35], v[20:23], v[44:47], v[32:35]
    v_lshrrev_b32 v19, 6, v2
    v_and_b32 v19, 8, v19
    v_mfma_f32_16x16x32_bf16 v[28:31], v[24:27], a[108:111], v[28:31]
    s_waitcnt lgkmcnt(0)
    v_mfma_f32_16x16x32_bf16 v[32:35], v[24:27], v[12:15], v[32:35]
    v_and_or_b32 v19, v2, s66, v19
S_D_st:
    v_mov_b32 v18, 0
    s_nop 6
    v_mov_b32_dpp v28, v28 row_ror:8 row_mask:0xc bank_mask:0x3
    v_mov_b32_dpp v29, v29 row_ror:8 row_mask:0xc bank_mask:0x3
    v_mov_b32_dpp v30, v30 row_ror:8 row_mask:0xc bank_mask:0x3
    v_mov_b32_dpp v31, v31 row_ror:8 row_mask:0xc bank_mask:0x3
    v_mov_b32_dpp v28, v32 row_ror:8 row_mask:0x3 bank_mask:0xc
    v_mov_b32_dpp v29, v33 row_ror:8 row_mask:0x3 bank_mask:0xc
    v_mov_b32_dpp v30, v34 row_ror:8 row_mask:0x3 bank_mask:0xc
    v_mov_b32_dpp v31, v35 row_ror:8 row_mask:0x3 bank_mask:0xc
    v_mov_b32_dpp v28, v32 quad_perm:[0,1,2,3] row_mask:0xc bank_mask:0xc
    v_mov_b32_dpp v29, v33 quad_perm:[0,1,2,3] row_mask:0xc bank_mask:0xc
    v_mov_b32_dpp v30, v34 quad_perm:[0,1,2,3] row_mask:0xc bank_mask:0xc
    v_mov_b32_dpp v31, v35 quad_perm:[0,1,2,3] row_mask:0xc bank_mask:0xc
    s_nop 0
    v_permlane32_swap_b32 v28, v30
    v_permlane32_swap_b32 v29, v31
    v_add_f32 v28, v28, v30
    v_add_f32 v29, v29, v31
    s_cmp_eq_u32 s51, 0
    s_cbranch_scc1 Lrs_144
    buffer_store_dwordx2 v[28:29], v19, s[24:27], s45 offen
    s_mov_b32 exec_hi, 0x80000000
    s_mov_b32 exec_lo, 0
    buffer_store_dwordx2 v[42:43], v18, s[24:27], s46 offen
    s_mov_b64 exec, -1
    s_branch Lrs_145
Lrs_144:
    buffer_store_dwordx2 v[28:29], v19, s[24:27], s45 offen sc1
    s_mov_b32 exec_hi, 0x80000000
    s_mov_b32 exec_lo, 0
    buffer_store_dwordx2 v[42:43], v18, s[24:27], s46 offen sc1
    s_mov_b64 exec, -1
Lrs_145:
    s_setpc_b64 s[78:79]
L_code_end:
    s_endpgm
.section .rodata,"a"
.p2align 6
.amdhsa_kernel interleave_layers__gqa_block_cached__gqa_block_cached__decode_kernel
  .amdhsa_next_free_vgpr 512
  .amdhsa_next_free_sgpr 102
  .amdhsa_accum_offset 256
  .amdhsa_group_segment_fixed_size 0
  .amdhsa_kernarg_size 104
  .amdhsa_user_sgpr_count 2
  .amdhsa_user_sgpr_kernarg_segment_ptr 1
  .amdhsa_system_sgpr_workgroup_id_x 1
.end_amdhsa_kernel
```
